```python
import torch

def _softmax(x, axis=-1):
    return torch.softmax(x, dim=axis)
def _gelu(x):
    return torch.nn.functional.gelu(x, approximate="tanh")
def _silu(x):
    return torch.nn.functional.silu(x)
def _sigmoid(x):
    return torch.sigmoid(x)
def _layernorm(x, axis=-1, eps=1e-5):
    m = x.mean(dim=axis, keepdim=True)
    v = x.var(dim=axis, keepdim=True, unbiased=False)
    return (x - m) / torch.sqrt(v + eps)
def _scatter_add(tgt, idx, src, axis=0):
    return tgt.clone().index_add_(axis, idx, src)
def _segment_sum(src, seg, n):
    out = torch.zeros((n,) + src.shape[1:], dtype=src.dtype)
    return out.index_add_(0, seg, src)
def _pad(x, pw):
    flat = tuple(v for pair in reversed(pw) for v in pair)
    return torch.nn.functional.pad(x, flat)

kernel_name = 'sequential_preLN__gqa_block_cached__geglu_ffn__decode'

def setup_inputs():

    _w = (lambda a: (lambda t: t.to(torch.bfloat16) if t.is_floating_point() else t)(torch.as_tensor(a)))
    def _A_setup():
        B, Sq, D = 4, 1, 640
        Hq, Hkv, Sk, Dh = 32, 32, 4096, 128
        assert Hq % Hkv == 0, (Hq, Hkv)
        return {
            "x": _w((lambda *s: torch.randn(*s, dtype=torch.bfloat16) * 0.05)(B, Sq, D)),
            "k_cache": _w((lambda *s: torch.randn(*s, dtype=torch.bfloat16) * 3.2)(B, Hkv, Sk, Dh)),
            "v_cache": _w((lambda *s: torch.randn(*s, dtype=torch.bfloat16) * 0.4)(B, Hkv, Sk, Dh)),
            "wq": _w((lambda *s: torch.randn(*s, dtype=torch.bfloat16) * 3.2)(D, Hq * Dh) * (D ** -0.5)),
            "wo": _w((lambda *s: torch.randn(*s, dtype=torch.bfloat16) * 0.4)(Hq * Dh, D) * ((Hq * Dh) ** -0.5)),
        }
    _A_in = _A_setup()

    def _B_setup():
        B, S, D, F = 4, 1, 640, 1728
        return {
            "x": _w((lambda *s: torch.randn(*s, dtype=torch.bfloat16) * 0.05)(B, S, D)),
            "w_gate": _w((lambda *s: torch.randn(*s, dtype=torch.bfloat16) * 0.05)(D, F)),
            "w_up": _w((lambda *s: torch.randn(*s, dtype=torch.bfloat16) * 0.05)(D, F)),
            "w_down": _w((lambda *s: torch.randn(*s, dtype=torch.bfloat16) * 0.05)(F, D)),
        }
    _B_in = _B_setup()

    return {
        "A_x": _A_in["x"],
        "A_k_cache": _A_in["k_cache"],
        "A_v_cache": _A_in["v_cache"],
        "A_wq": _A_in["wq"],
        "A_wo": _A_in["wo"],
        "B_x": _B_in["x"],
        "B_w_gate": _B_in["w_gate"],
        "B_w_up": _B_in["w_up"],
        "B_w_down": _B_in["w_down"],
    }

def reference(A_x, A_k_cache, A_v_cache, A_wq, A_wo, B_x, B_w_gate, B_w_up, B_w_down):
    def _A_ref(x, k_cache, v_cache, wq, wo):
        B, Sq, D = x.shape
        Hq, Dh = 32, 128
        Hkv = k_cache.shape[1]
        rep = Hq // Hkv
        q = (lambda x, *d: x.permute(*d))((x @ wq).reshape(B, Sq, Hq, Dh), 0, 2, 1, 3)
        k = (lambda x, n, axis: torch.repeat_interleave(x, n, dim=axis))(k_cache, rep, axis=1)
        v = (lambda x, n, axis: torch.repeat_interleave(x, n, dim=axis))(v_cache, rep, axis=1)
        scores = torch.einsum("bhqd,bhkd->bhqk", q, k) * (Dh ** -0.5)
        p = _softmax(scores, axis=-1)
        o = torch.einsum("bhqk,bhkd->bhqd", p, v)
        return (lambda x, *d: x.permute(*d))(o, 0, 2, 1, 3).reshape(B, Sq, Hq * Dh) @ wo

    def _B_ref(x, w_gate, w_up, w_down):
        return (_gelu(x @ w_gate) * (x @ w_up)) @ w_down

    x = A_x
    h = x + _A_ref(_layernorm(x, axis=-1), A_k_cache, A_v_cache, A_wq, A_wo)
    h2 = h + _B_ref(_layernorm(h, axis=-1), B_w_gate, B_w_up, B_w_down)
    return h2
```

```asm
; @launch grid=(256,1,1) block=(512,1,1) lds=124928
.amdgcn_target "amdgcn-amd-amdhsa--gfx950"
.text
.globl sequential_preLN__gqa_block_cached__geglu_ffn__decode_kernel
.p2align 8
.type sequential_preLN__gqa_block_cached__geglu_ffn__decode_kernel,@function
sequential_preLN__gqa_block_cached__geglu_ffn__decode_kernel:
  s_cmp_ge_u32 s2, 256
  s_cbranch_scc1 L_end
  s_load_dwordx16 s[16:31], s[0:1], 0
  s_load_dwordx8 s[32:39], s[0:1], 64
  v_and_b32 v1, 63, v0
  v_lshrrev_b32 v6, 6, v0
  s_nop 0
  v_readfirstlane_b32 s3, v6
  v_and_b32 v2, 15, v0
  v_lshrrev_b32 v3, 4, v1
  v_lshlrev_b32 v4, 4, v1
  s_and_b32 s4, s2, 31
  s_lshr_b32 s65, s2, 5
  s_lshr_b32 s5, s65, 1
  s_and_b32 s6, s65, 1
  s_lshl_b32 s10, s5, 5
  s_add_u32 s10, s10, s4
  s_lshl_b32 s10, s10, 1
  s_add_u32 s10, s10, s6
  s_lshl_b32 s7, s10, 19
  s_lshl_b32 s8, s3, 12
  s_add_u32 s7, s7, s8
  s_mul_i32 s11, s3, 2
  s_and_b32 s69, s3, 3
  s_mul_i32 s8, s65, 80
  s_lshl_b32 s9, s3, 2
  s_add_u32 s8, s8, s9
  v_add_u32 v182, s8, v3
  v_lshlrev_b32 v183, 13, v182
  v_lshl_add_u32 v183, v2, 4, v183
  v_lshlrev_b32 v6, 2, v1
  s_mul_i32 s8, s69, 1280
  v_mov_b32 v7, 0x45000
  s_waitcnt lgkmcnt(0)
  s_mov_b32 s56, s16
  s_mov_b32 s57, s17
  s_mov_b32 s58, 0x1400
  s_mov_b32 s59, 0x20000
  s_mov_b32 s76, s38
  s_mov_b32 s77, s39
  s_mov_b32 s78, 0x2d7000
  s_mov_b32 s79, 0x20000
  buffer_load_dword v176, v6, s[56:59], s8 offen offset:0
  buffer_load_dword v177, v6, s[56:59], s8 offen offset:256
  buffer_load_dword v178, v6, s[56:59], s8 offen offset:512
  buffer_load_dword v179, v6, s[56:59], s8 offen offset:768
  buffer_load_dword v180, v6, s[56:59], s8 offen offset:1024
  buffer_load_dword v40, v7, s[76:79], 0 offen sc1
  s_mov_b32 s48, s22
  s_mov_b32 s49, s23
  s_mov_b32 s50, 0x500000
  s_mov_b32 s51, 0x20000
  s_lshl_b32 s8, s4, 8
  s_add_u32 s9, s8, 262144
  buffer_load_dwordx4 v[228:231], v183, s[48:51], s8 offen
  buffer_load_dwordx4 v[232:235], v183, s[48:51], s9 offen
  s_add_u32 s9, s8, 524288
  s_cmp_lt_u32 s3, 4
  s_cselect_b32 s9, s9, 0x40000000
  buffer_load_dwordx4 v[236:239], v183, s[48:51], s9 offen
  s_mov_b32 s40, s18
  s_mov_b32 s41, s19
  s_mov_b32 s42, 0x8000000
  s_mov_b32 s43, 0x20000
  s_mov_b32 s44, s20
  s_mov_b32 s45, s21
  s_mov_b32 s46, 0x8000000
  s_mov_b32 s47, 0x20000
  s_barrier
  s_add_u32 s100, s11, 0
  s_and_b32 s100, s100, 15
  s_lshl_b32 s100, s100, 15
  s_add_u32 s100, s100, s7
  buffer_load_dwordx4 v[48:51], v4, s[40:43], s100 offen offset:0 nt
  buffer_load_dwordx4 v[52:55], v4, s[40:43], s100 offen offset:1024 nt
  buffer_load_dwordx4 v[56:59], v4, s[40:43], s100 offen offset:2048 nt
  buffer_load_dwordx4 v[60:63], v4, s[40:43], s100 offen offset:3072 nt
  s_add_u32 s100, s11, 0
  s_and_b32 s100, s100, 15
  s_lshl_b32 s100, s100, 15
  s_add_u32 s100, s100, s7
  buffer_load_dwordx4 v[80:83], v4, s[44:47], s100 offen offset:0 nt
  buffer_load_dwordx4 v[84:87], v4, s[44:47], s100 offen offset:1024 nt
  buffer_load_dwordx4 v[88:91], v4, s[44:47], s100 offen offset:2048 nt
  buffer_load_dwordx4 v[92:95], v4, s[44:47], s100 offen offset:3072 nt
  s_mov_b32 s52, s24
  s_mov_b32 s53, s25
  s_mov_b32 s54, 0x500000
  s_mov_b32 s55, 0x20000
  s_mov_b32 s80, s34
  s_mov_b32 s81, s35
  s_mov_b32 s82, 0x1400
  s_mov_b32 s83, 0x20000
  s_mov_b32 s88, s36
  s_mov_b32 s89, s37
  s_mov_b32 s90, 0x100
  s_mov_b32 s91, 0x20000
  s_getreg_b32 s101, hwreg(HW_REG_XCC_ID)
  s_and_b32 s101, s101, 7
  v_and_b32 v41, 1, v3
  v_lshlrev_b32 v41, 1, v41
  v_lshrrev_b32 v6, 1, v3
  v_or_b32 v41, v41, v6
  v_lshlrev_b32 v5, 2, v41
  v_lshl_add_u32 v5, v2, 5, v5
  v_lshrrev_b32 v6, 1, v1
  v_and_b32 v7, 1, v1
  s_lshl_b32 s8, s3, 4
  v_lshlrev_b32 v8, 2, v3
  v_add_u32 v8, s8, v8
  v_mul_u32_u24 v45, 1280, v8
  v_lshl_add_u32 v45, v2, 4, v45
  v_lshlrev_b32 v47, 2, v8
  s_mul_i32 s8, s69, 160
  v_add_u32 v6, s8, v6
  v_mul_u32_u24 v38, 3456, v6
  v_lshl_add_u32 v38, v7, 4, v38
  v_mul_u32_u24 v39, 1280, v3
  v_lshl_add_u32 v39, v2, 4, v39
  s_mul_i32 s8, s3, 5120
  v_add_u32 v43, s8, v4
  v_bfe_u32 v7, v1, 2, 2
  v_lshl_add_u32 v7, v3, 3, v7
  v_and_b32 v8, 3, v1
  v_lshlrev_b32 v8, 3, v8
  v_lshl_add_u32 v7, v7, 5, v8
  v_add_u32 v44, s8, v7
  s_mov_b32 s15, 0x1000000
  s_waitcnt vmcnt(11)
  v_readfirstlane_b32 s13, v40
  v_lshlrev_b32 v192, 16, v176
  v_and_b32 v193, 0xffff0000, v176
  v_lshlrev_b32 v194, 16, v177
  v_and_b32 v195, 0xffff0000, v177
  v_lshlrev_b32 v196, 16, v178
  v_and_b32 v197, 0xffff0000, v178
  v_lshlrev_b32 v198, 16, v179
  v_and_b32 v199, 0xffff0000, v179
  v_lshlrev_b32 v200, 16, v180
  v_and_b32 v201, 0xffff0000, v180
  s_add_u32 s13, s13, 1
  v_add_f32 v202, v192, v193
  v_add_f32 v202, v202, v194
  v_add_f32 v202, v202, v195
  v_add_f32 v202, v202, v196
  v_add_f32 v202, v202, v197
  v_add_f32 v202, v202, v198
  v_add_f32 v202, v202, v199
  v_add_f32 v202, v202, v200
  v_add_f32 v202, v202, v201
  s_nop 1
  v_add_f32_dpp v202, v202, v202 row_ror:8 row_mask:0xf bank_mask:0xf
  s_nop 1
  v_add_f32_dpp v202, v202, v202 row_ror:4 row_mask:0xf bank_mask:0xf
  s_nop 1
  v_add_f32_dpp v202, v202, v202 row_ror:2 row_mask:0xf bank_mask:0xf
  s_nop 1
  v_add_f32_dpp v202, v202, v202 row_ror:1 row_mask:0xf bank_mask:0xf
  v_mov_b32 v203, v202
  s_nop 1
  v_permlane32_swap_b32 v203, v202
  v_add_f32 v202, v203, v202
  v_mov_b32 v203, v202
  s_nop 1
  v_permlane16_swap_b32 v203, v202
  v_add_f32 v202, v203, v202
  v_mul_f32 v204, 0x3acccccd, v202
  v_sub_f32 v208, v192, v204
  v_sub_f32 v209, v193, v204
  v_sub_f32 v210, v194, v204
  v_sub_f32 v211, v195, v204
  v_sub_f32 v212, v196, v204
  v_sub_f32 v213, v197, v204
  v_sub_f32 v214, v198, v204
  v_sub_f32 v215, v199, v204
  v_sub_f32 v216, v200, v204
  v_sub_f32 v217, v201, v204
  v_mul_f32 v202, v208, v208
  v_fmac_f32 v202, v209, v209
  v_fmac_f32 v202, v210, v210
  v_fmac_f32 v202, v211, v211
  v_fmac_f32 v202, v212, v212
  v_fmac_f32 v202, v213, v213
  v_fmac_f32 v202, v214, v214
  v_fmac_f32 v202, v215, v215
  v_fmac_f32 v202, v216, v216
  v_fmac_f32 v202, v217, v217
  s_nop 1
  v_add_f32_dpp v202, v202, v202 row_ror:8 row_mask:0xf bank_mask:0xf
  s_nop 1
  v_add_f32_dpp v202, v202, v202 row_ror:4 row_mask:0xf bank_mask:0xf
  s_nop 1
  v_add_f32_dpp v202, v202, v202 row_ror:2 row_mask:0xf bank_mask:0xf
  s_nop 1
  v_add_f32_dpp v202, v202, v202 row_ror:1 row_mask:0xf bank_mask:0xf
  v_mov_b32 v203, v202
  s_nop 1
  v_permlane32_swap_b32 v203, v202
  v_add_f32 v202, v203, v202
  v_mov_b32 v203, v202
  s_nop 1
  v_permlane16_swap_b32 v203, v202
  v_add_f32 v202, v203, v202
  v_mul_f32 v205, 0x3acccccd, v202
  v_cvt_pk_bf16_f32 v206, v204, v204
  v_and_b32 v206, 0xffff0000, v206
  v_cvt_pk_bf16_f32 v205, v205, v205
  v_and_b32 v205, 0xffff0000, v205
  v_add_f32 v205, 0x3727c5ac, v205
  v_cvt_pk_bf16_f32 v205, v205, v205
  v_and_b32 v205, 0xffff0000, v205
  v_sqrt_f32 v207, v205
  s_nop 0
  v_cvt_pk_bf16_f32 v207, v207, v207
  v_and_b32 v207, 0xffff0000, v207
  v_rcp_f32 v202, v207
  v_sub_f32 v192, v192, v206
  v_sub_f32 v193, v193, v206
  v_sub_f32 v194, v194, v206
  v_sub_f32 v195, v195, v206
  v_sub_f32 v196, v196, v206
  v_sub_f32 v197, v197, v206
  v_sub_f32 v198, v198, v206
  v_sub_f32 v199, v199, v206
  v_sub_f32 v200, v200, v206
  v_sub_f32 v201, v201, v206
  v_cvt_pk_bf16_f32 v192, v192, v192
  v_and_b32 v192, 0xffff0000, v192
  v_cvt_pk_bf16_f32 v193, v193, v193
  v_and_b32 v193, 0xffff0000, v193
  v_cvt_pk_bf16_f32 v194, v194, v194
  v_and_b32 v194, 0xffff0000, v194
  v_cvt_pk_bf16_f32 v195, v195, v195
  v_and_b32 v195, 0xffff0000, v195
  v_cvt_pk_bf16_f32 v196, v196, v196
  v_and_b32 v196, 0xffff0000, v196
  v_cvt_pk_bf16_f32 v197, v197, v197
  v_and_b32 v197, 0xffff0000, v197
  v_cvt_pk_bf16_f32 v198, v198, v198
  v_and_b32 v198, 0xffff0000, v198
  v_cvt_pk_bf16_f32 v199, v199, v199
  v_and_b32 v199, 0xffff0000, v199
  v_cvt_pk_bf16_f32 v200, v200, v200
  v_and_b32 v200, 0xffff0000, v200
  v_cvt_pk_bf16_f32 v201, v201, v201
  v_and_b32 v201, 0xffff0000, v201
  v_mul_f32 v208, v192, v202
  v_mul_f32 v209, v193, v202
  v_mul_f32 v210, v194, v202
  v_mul_f32 v211, v195, v202
  v_mul_f32 v212, v196, v202
  v_mul_f32 v213, v197, v202
  v_mul_f32 v214, v198, v202
  v_mul_f32 v215, v199, v202
  v_mul_f32 v216, v200, v202
  v_mul_f32 v217, v201, v202
  v_fma_f32 v192, -v208, v207, v192
  v_fma_f32 v193, -v209, v207, v193
  v_fma_f32 v194, -v210, v207, v194
  v_fma_f32 v195, -v211, v207, v195
  v_fma_f32 v196, -v212, v207, v196
  v_fma_f32 v197, -v213, v207, v197
  v_fma_f32 v198, -v214, v207, v198
  v_fma_f32 v199, -v215, v207, v199
  v_fma_f32 v200, -v216, v207, v200
  v_fma_f32 v201, -v217, v207, v201
  v_fmac_f32 v208, v192, v202
  v_fmac_f32 v209, v193, v202
  v_fmac_f32 v210, v194, v202
  v_fmac_f32 v211, v195, v202
  v_fmac_f32 v212, v196, v202
  v_fmac_f32 v213, v197, v202
  v_fmac_f32 v214, v198, v202
  v_fmac_f32 v215, v199, v202
  v_fmac_f32 v216, v200, v202
  v_fmac_f32 v217, v201, v202
  v_cvt_pk_bf16_f32 v192, v208, v208
  v_and_b32 v192, 0xffff0000, v192
  v_cvt_pk_bf16_f32 v193, v209, v209
  v_and_b32 v193, 0xffff0000, v193
  v_cvt_pk_bf16_f32 v194, v210, v210
  v_and_b32 v194, 0xffff0000, v194
  v_cvt_pk_bf16_f32 v195, v211, v211
  v_and_b32 v195, 0xffff0000, v195
  v_cvt_pk_bf16_f32 v196, v212, v212
  v_and_b32 v196, 0xffff0000, v196
  v_cvt_pk_bf16_f32 v197, v213, v213
  v_and_b32 v197, 0xffff0000, v197
  v_cvt_pk_bf16_f32 v198, v214, v214
  v_and_b32 v198, 0xffff0000, v198
  v_cvt_pk_bf16_f32 v199, v215, v215
  v_and_b32 v199, 0xffff0000, v199
  v_cvt_pk_bf16_f32 v200, v216, v216
  v_and_b32 v200, 0xffff0000, v200
  v_cvt_pk_bf16_f32 v201, v217, v217
  v_and_b32 v201, 0xffff0000, v201
  v_lshlrev_b32 v6, 5, v1
  s_lshl_b32 s8, s69, 2
  v_add_u32 v6, s8, v6
  ds_write_b32 v6, v192 offset:0
  ds_write_b32 v6, v193 offset:16
  ds_write_b32 v6, v194 offset:2048
  ds_write_b32 v6, v195 offset:2064
  ds_write_b32 v6, v196 offset:4096
  ds_write_b32 v6, v197 offset:4112
  ds_write_b32 v6, v198 offset:6144
  ds_write_b32 v6, v199 offset:6160
  ds_write_b32 v6, v200 offset:8192
  ds_write_b32 v6, v201 offset:8208
  v_lshlrev_b32 v7, 4, v182
  s_waitcnt lgkmcnt(0)
  v_mov_b32 v192, 0
  v_mov_b32 v193, 0
  v_mov_b32 v194, 0
  v_mov_b32 v195, 0
  v_mov_b32 v196, 0
  v_mov_b32 v197, 0
  v_mov_b32 v198, 0
  v_mov_b32 v199, 0
  v_mov_b32 v200, 0
  v_mov_b32 v201, 0
  v_mov_b32 v202, 0
  v_mov_b32 v203, 0
  v_mov_b32 v204, 0
  v_mov_b32 v205, 0
  v_mov_b32 v206, 0
  v_mov_b32 v207, 0
  v_mov_b32 v208, 0
  v_mov_b32 v209, 0
  v_mov_b32 v210, 0
  v_mov_b32 v211, 0
  v_mov_b32 v212, 0
  v_mov_b32 v213, 0
  v_mov_b32 v214, 0
  v_mov_b32 v215, 0
  v_mov_b32 v216, 0
  v_mov_b32 v217, 0
  v_mov_b32 v218, 0
  v_mov_b32 v219, 0
  v_mov_b32 v220, 0
  v_mov_b32 v221, 0
  v_mov_b32 v222, 0
  v_mov_b32 v223, 0
  s_barrier
  ds_read_b128 v[16:19], v7 offset:0
  ds_read_b128 v[20:23], v7 offset:512
  ds_read_b128 v[24:27], v7 offset:1024
  s_waitcnt vmcnt(8)
  s_waitcnt lgkmcnt(2)
  v_lshrrev_b32 v6, 16, v16
  v_dot2c_f32_bf16 v192, v228, v6
  v_dot2c_f32_bf16 v193, v228, v16
  v_dot2c_f32_bf16 v194, v229, v6
  v_dot2c_f32_bf16 v195, v229, v16
  v_dot2c_f32_bf16 v196, v230, v6
  v_dot2c_f32_bf16 v197, v230, v16
  v_dot2c_f32_bf16 v198, v231, v6
  v_dot2c_f32_bf16 v199, v231, v16
  v_lshrrev_b32 v6, 16, v17
  v_dot2c_f32_bf16 v200, v228, v6
  v_dot2c_f32_bf16 v201, v228, v17
  v_dot2c_f32_bf16 v202, v229, v6
  v_dot2c_f32_bf16 v203, v229, v17
  v_dot2c_f32_bf16 v204, v230, v6
  v_dot2c_f32_bf16 v205, v230, v17
  v_dot2c_f32_bf16 v206, v231, v6
  v_dot2c_f32_bf16 v207, v231, v17
  v_lshrrev_b32 v6, 16, v18
  v_dot2c_f32_bf16 v208, v228, v6
  v_dot2c_f32_bf16 v209, v228, v18
  v_dot2c_f32_bf16 v210, v229, v6
  v_dot2c_f32_bf16 v211, v229, v18
  v_dot2c_f32_bf16 v212, v230, v6
  v_dot2c_f32_bf16 v213, v230, v18
  v_dot2c_f32_bf16 v214, v231, v6
  v_dot2c_f32_bf16 v215, v231, v18
  v_lshrrev_b32 v6, 16, v19
  v_dot2c_f32_bf16 v216, v228, v6
  v_dot2c_f32_bf16 v217, v228, v19
  v_dot2c_f32_bf16 v218, v229, v6
  v_dot2c_f32_bf16 v219, v229, v19
  v_dot2c_f32_bf16 v220, v230, v6
  v_dot2c_f32_bf16 v221, v230, v19
  v_dot2c_f32_bf16 v222, v231, v6
  v_dot2c_f32_bf16 v223, v231, v19
  s_waitcnt lgkmcnt(1)
  v_lshrrev_b32 v6, 16, v20
  v_dot2c_f32_bf16 v192, v232, v6
  v_dot2c_f32_bf16 v193, v232, v20
  v_dot2c_f32_bf16 v194, v233, v6
  v_dot2c_f32_bf16 v195, v233, v20
  v_dot2c_f32_bf16 v196, v234, v6
  v_dot2c_f32_bf16 v197, v234, v20
  v_dot2c_f32_bf16 v198, v235, v6
  v_dot2c_f32_bf16 v199, v235, v20
  v_lshrrev_b32 v6, 16, v21
  v_dot2c_f32_bf16 v200, v232, v6
  v_dot2c_f32_bf16 v201, v232, v21
  v_dot2c_f32_bf16 v202, v233, v6
  v_dot2c_f32_bf16 v203, v233, v21
  v_dot2c_f32_bf16 v204, v234, v6
  v_dot2c_f32_bf16 v205, v234, v21
  v_dot2c_f32_bf16 v206, v235, v6
  v_dot2c_f32_bf16 v207, v235, v21
  v_lshrrev_b32 v6, 16, v22
  v_dot2c_f32_bf16 v208, v232, v6
  v_dot2c_f32_bf16 v209, v232, v22
  v_dot2c_f32_bf16 v210, v233, v6
  v_dot2c_f32_bf16 v211, v233, v22
  v_dot2c_f32_bf16 v212, v234, v6
  v_dot2c_f32_bf16 v213, v234, v22
  v_dot2c_f32_bf16 v214, v235, v6
  v_dot2c_f32_bf16 v215, v235, v22
  v_lshrrev_b32 v6, 16, v23
  v_dot2c_f32_bf16 v216, v232, v6
  v_dot2c_f32_bf16 v217, v232, v23
  v_dot2c_f32_bf16 v218, v233, v6
  v_dot2c_f32_bf16 v219, v233, v23
  v_dot2c_f32_bf16 v220, v234, v6
  v_dot2c_f32_bf16 v221, v234, v23
  v_dot2c_f32_bf16 v222, v235, v6
  v_dot2c_f32_bf16 v223, v235, v23
  s_waitcnt lgkmcnt(0)
  s_cmp_lt_u32 s3, 4
  s_cselect_b32 s8, -1, 0
  v_and_b32 v24, s8, v24
  v_and_b32 v25, s8, v25
  v_and_b32 v26, s8, v26
  v_and_b32 v27, s8, v27
  v_lshrrev_b32 v6, 16, v24
  v_dot2c_f32_bf16 v192, v236, v6
  v_dot2c_f32_bf16 v193, v236, v24
  v_dot2c_f32_bf16 v194, v237, v6
  v_dot2c_f32_bf16 v195, v237, v24
  v_dot2c_f32_bf16 v196, v238, v6
  v_dot2c_f32_bf16 v197, v238, v24
  v_dot2c_f32_bf16 v198, v239, v6
  v_dot2c_f32_bf16 v199, v239, v24
  v_lshrrev_b32 v6, 16, v25
  v_dot2c_f32_bf16 v200, v236, v6
  v_dot2c_f32_bf16 v201, v236, v25
  v_dot2c_f32_bf16 v202, v237, v6
  v_dot2c_f32_bf16 v203, v237, v25
  v_dot2c_f32_bf16 v204, v238, v6
  v_dot2c_f32_bf16 v205, v238, v25
  v_dot2c_f32_bf16 v206, v239, v6
  v_dot2c_f32_bf16 v207, v239, v25
  v_lshrrev_b32 v6, 16, v26
  v_dot2c_f32_bf16 v208, v236, v6
  v_dot2c_f32_bf16 v209, v236, v26
  v_dot2c_f32_bf16 v210, v237, v6
  v_dot2c_f32_bf16 v211, v237, v26
  v_dot2c_f32_bf16 v212, v238, v6
  v_dot2c_f32_bf16 v213, v238, v26
  v_dot2c_f32_bf16 v214, v239, v6
  v_dot2c_f32_bf16 v215, v239, v26
  v_lshrrev_b32 v6, 16, v27
  v_dot2c_f32_bf16 v216, v236, v6
  v_dot2c_f32_bf16 v217, v236, v27
  v_dot2c_f32_bf16 v218, v237, v6
  v_dot2c_f32_bf16 v219, v237, v27
  v_dot2c_f32_bf16 v220, v238, v6
  v_dot2c_f32_bf16 v221, v238, v27
  v_dot2c_f32_bf16 v222, v239, v6
  v_dot2c_f32_bf16 v223, v239, v27
  v_permlane32_swap_b32 v192, v193
  v_permlane32_swap_b32 v194, v195
  v_permlane32_swap_b32 v196, v197
  v_permlane32_swap_b32 v198, v199
  v_permlane32_swap_b32 v200, v201
  v_permlane32_swap_b32 v202, v203
  v_permlane32_swap_b32 v204, v205
  v_permlane32_swap_b32 v206, v207
  v_permlane32_swap_b32 v208, v209
  v_permlane32_swap_b32 v210, v211
  v_permlane32_swap_b32 v212, v213
  v_permlane32_swap_b32 v214, v215
  v_permlane32_swap_b32 v216, v217
  v_permlane32_swap_b32 v218, v219
  v_permlane32_swap_b32 v220, v221
  v_permlane32_swap_b32 v222, v223
  v_add_f32 v192, v192, v193
  v_add_f32 v194, v194, v195
  v_add_f32 v196, v196, v197
  v_add_f32 v198, v198, v199
  v_add_f32 v200, v200, v201
  v_add_f32 v202, v202, v203
  v_add_f32 v204, v204, v205
  v_add_f32 v206, v206, v207
  v_add_f32 v208, v208, v209
  v_add_f32 v210, v210, v211
  v_add_f32 v212, v212, v213
  v_add_f32 v214, v214, v215
  v_add_f32 v216, v216, v217
  v_add_f32 v218, v218, v219
  v_add_f32 v220, v220, v221
  v_add_f32 v222, v222, v223
  v_permlane16_swap_b32 v192, v194
  v_permlane16_swap_b32 v196, v198
  v_permlane16_swap_b32 v200, v202
  v_permlane16_swap_b32 v204, v206
  v_permlane16_swap_b32 v208, v210
  v_permlane16_swap_b32 v212, v214
  v_permlane16_swap_b32 v216, v218
  v_permlane16_swap_b32 v220, v222
  v_add_f32 v192, v192, v194
  v_add_f32 v196, v196, v198
  v_add_f32 v200, v200, v202
  v_add_f32 v204, v204, v206
  v_add_f32 v208, v208, v210
  v_add_f32 v212, v212, v214
  v_add_f32 v216, v216, v218
  v_add_f32 v220, v220, v222
  s_lshl_b32 s8, s3, 11
  v_add_u32 v6, s8, v5
  ds_write_b32 v6, v192 offset:10240
  ds_write_b32 v6, v196 offset:10256
  ds_write_b32 v6, v200 offset:10752
  ds_write_b32 v6, v204 offset:10768
  ds_write_b32 v6, v208 offset:11264
  ds_write_b32 v6, v212 offset:11280
  ds_write_b32 v6, v216 offset:11776
  ds_write_b32 v6, v220 offset:11792
  v_mov_b32 v7, 0
  ds_write_b32 v7, v7 offset:41984
  v_mov_b32 v8, -1
  ds_write_b32 v7, v8 offset:41988
  s_waitcnt lgkmcnt(0)
  s_barrier
  s_cmp_ge_u32 s3, 4
  s_cbranch_scc1 L_qpubdone
  v_lshlrev_b32 v6, 3, v0
  ds_read_b64 v[192:193], v6 offset:10240
  ds_read_b64 v[194:195], v6 offset:12288
  ds_read_b64 v[196:197], v6 offset:14336
  ds_read_b64 v[198:199], v6 offset:16384
  ds_read_b64 v[200:201], v6 offset:18432
  ds_read_b64 v[202:203], v6 offset:20480
  ds_read_b64 v[204:205], v6 offset:22528
  ds_read_b64 v[206:207], v6 offset:24576
  s_lshl_b32 s8, s4, 3
  s_add_u32 s8, s8, s65
  s_lshl_b32 s8, s8, 12
  s_add_u32 s8, s8, 0x50000
  v_lshlrev_b32 v7, 4, v0
  v_mov_b32 v185, s13
  v_mov_b32 v187, s13
  s_waitcnt lgkmcnt(0)
  v_pk_add_f32 v[192:193], v[192:193], v[194:195]
  v_pk_add_f32 v[196:197], v[196:197], v[198:199]
  v_pk_add_f32 v[200:201], v[200:201], v[202:203]
  v_pk_add_f32 v[204:205], v[204:205], v[206:207]
  v_pk_add_f32 v[192:193], v[192:193], v[196:197]
  v_pk_add_f32 v[200:201], v[200:201], v[204:205]
  v_add_f32 v184, v192, v200
  v_add_f32 v186, v193, v201
  buffer_store_dwordx4 v[184:187], v7, s[76:79], s8 offen sc1
  s_nop 4
L_qpubdone:
  s_add_u32 s100, s11, 1
  s_and_b32 s100, s100, 15
  s_lshl_b32 s100, s100, 15
  s_add_u32 s100, s100, s7
  buffer_load_dwordx4 v[64:67], v4, s[40:43], s100 offen offset:0 nt
  buffer_load_dwordx4 v[68:71], v4, s[40:43], s100 offen offset:1024 nt
  buffer_load_dwordx4 v[72:75], v4, s[40:43], s100 offen offset:2048 nt
  buffer_load_dwordx4 v[76:79], v4, s[40:43], s100 offen offset:3072 nt
  s_add_u32 s100, s11, 1
  s_and_b32 s100, s100, 15
  s_lshl_b32 s100, s100, 15
  s_add_u32 s100, s100, s7
  buffer_load_dwordx4 v[96:99], v4, s[44:47], s100 offen offset:0 nt
  buffer_load_dwordx4 v[100:103], v4, s[44:47], s100 offen offset:1024 nt
  buffer_load_dwordx4 v[104:107], v4, s[44:47], s100 offen offset:2048 nt
  buffer_load_dwordx4 v[108:111], v4, s[44:47], s100 offen offset:3072 nt
  s_lshl_b32 s8, s4, 3
  s_add_u32 s8, s8, s3
  s_lshl_b32 s8, s8, 2
  s_add_u32 s8, s8, s5
  s_lshl_b32 s8, s8, 10
  s_add_u32 s8, s8, 0x50000
  v_add_u32 v8, s8, v4
  v_mov_b32 v16, 0
  v_mov_b32 v17, 0
  v_mov_b32 v18, 0
  v_mov_b32 v19, 0
  v_mov_b32 v20, 0
  v_mov_b32 v21, 0
  v_mov_b32 v22, 0
  v_mov_b32 v23, 0
  v_mov_b32 v28, 0xff7fffff
  v_mov_b32 v29, 0
  s_waitcnt vmcnt(4)
  s_mov_b32 s62, 0
  s_cmp_lg_u32 s62, 0
  s_cbranch_scc1 L_qs_1
  buffer_load_dwordx4 v[188:191], v8, s[76:79], 0 offen sc1
L_qs_1:
  s_add_u32 s100, s11, 2
  s_and_b32 s100, s100, 15
  s_lshl_b32 s100, s100, 15
  s_add_u32 s100, s100, s7
  buffer_load_dwordx4 v[112:115], v4, s[40:43], s100 offen offset:0 nt
  buffer_load_dwordx4 v[116:119], v4, s[40:43], s100 offen offset:1024 nt
  buffer_load_dwordx4 v[120:123], v4, s[40:43], s100 offen offset:2048 nt
  buffer_load_dwordx4 v[124:127], v4, s[40:43], s100 offen offset:3072 nt
  s_cmp_lg_u32 s62, 0
  s_cbranch_scc1 L_qs_2
  s_waitcnt vmcnt(4)
  v_xor_b32 v6, s13, v189
  v_xor_b32 v7, s13, v191
  v_or_b32 v6, v6, v7
  v_cmp_ne_u32 vcc, 0, v6
  s_nop 1
  s_cmp_eq_u64 vcc, 0
  s_cselect_b32 s62, 1, 0
  s_cbranch_scc0 L_qs_2
  v_mov_b32 v189, v190
  v_lshlrev_b32 v6, 3, v0
  ds_write_b64 v6, v[188:189] offset:26624
  v_mov_b32 v6, 0
  v_mov_b32 v7, 1
  s_waitcnt lgkmcnt(0)
  s_mov_b64 exec, 1
  ds_add_u32 v6, v7 offset:41984
  s_mov_b64 exec, -1
L_qs_2:
  s_cmp_lg_u32 s62, 0
  s_cbranch_scc1 L_qs_3
  buffer_load_dwordx4 v[188:191], v8, s[76:79], 0 offen sc1
L_qs_3:
  s_add_u32 s100, s11, 2
  s_and_b32 s100, s100, 15
  s_lshl_b32 s100, s100, 15
  s_add_u32 s100, s100, s7
  buffer_load_dwordx4 v[128:131], v4, s[44:47], s100 offen offset:0 nt
  buffer_load_dwordx4 v[132:135], v4, s[44:47], s100 offen offset:1024 nt
  buffer_load_dwordx4 v[136:139], v4, s[44:47], s100 offen offset:2048 nt
  buffer_load_dwordx4 v[140:143], v4, s[44:47], s100 offen offset:3072 nt
  s_cmp_lg_u32 s62, 0
  s_cbranch_scc1 L_qs_4
  s_waitcnt vmcnt(4)
  v_xor_b32 v6, s13, v189
  v_xor_b32 v7, s13, v191
  v_or_b32 v6, v6, v7
  v_cmp_ne_u32 vcc, 0, v6
  s_nop 1
  s_cmp_eq_u64 vcc, 0
  s_cselect_b32 s62, 1, 0
  s_cbranch_scc0 L_qs_4
  v_mov_b32 v189, v190
  v_lshlrev_b32 v6, 3, v0
  ds_write_b64 v6, v[188:189] offset:26624
  v_mov_b32 v6, 0
  v_mov_b32 v7, 1
  s_waitcnt lgkmcnt(0)
  s_mov_b64 exec, 1
  ds_add_u32 v6, v7 offset:41984
  s_mov_b64 exec, -1
L_qs_4:
  s_cmp_lg_u32 s62, 0
  s_cbranch_scc1 L_qok
  s_branch L_q_poll
L_q_retry:
  s_sleep 1
L_q_poll:
  buffer_load_dwordx4 v[188:191], v8, s[76:79], 0 offen sc1
  s_waitcnt vmcnt(0)
  v_xor_b32 v6, s13, v189
  v_xor_b32 v7, s13, v191
  v_or_b32 v6, v6, v7
  v_cmp_ne_u32 vcc, 0, v6
  s_sub_u32 s15, s15, 1
  s_cbranch_scc1 L_end
  s_cbranch_vccnz L_q_retry
  v_mov_b32 v189, v190
  v_lshlrev_b32 v6, 3, v0
  ds_write_b64 v6, v[188:189] offset:26624
  v_mov_b32 v6, 0
  v_mov_b32 v7, 1
  s_waitcnt lgkmcnt(0)
  s_mov_b64 exec, 1
  ds_add_u32 v6, v7 offset:41984
  s_mov_b64 exec, -1
L_qok:
  v_lshlrev_b32 v7, 3, v1
  v_mov_b32 v6, 0
L_qspin:
  ds_read_b32 v8, v6 offset:41984
  s_waitcnt lgkmcnt(0)
  v_readfirstlane_b32 s8, v8
  s_nop 1
  s_cmp_ge_u32 s8, 8
  s_cbranch_scc1 L_qgo
  s_sub_u32 s15, s15, 1
  s_cbranch_scc1 L_end
  s_sleep 1
  s_branch L_qspin
L_qgo:
  ds_read_b64 v[192:193], v7 offset:26624
  ds_read_b64 v[194:195], v7 offset:27136
  ds_read_b64 v[196:197], v7 offset:27648
  ds_read_b64 v[198:199], v7 offset:28160
  ds_read_b64 v[200:201], v7 offset:28672
  ds_read_b64 v[202:203], v7 offset:29184
  ds_read_b64 v[204:205], v7 offset:29696
  ds_read_b64 v[206:207], v7 offset:30208
  s_lshl_b32 s8, s3, 8
  v_lshlrev_b32 v6, 2, v1
  v_add_u32 v6, s8, v6
  v_lshlrev_b32 v7, 4, v2
  v_add_u32 v7, s8, v7
  s_waitcnt lgkmcnt(0)
  v_pk_add_f32 v[192:193], v[192:193], v[194:195]
  v_pk_add_f32 v[196:197], v[196:197], v[198:199]
  v_pk_add_f32 v[200:201], v[200:201], v[202:203]
  v_pk_add_f32 v[204:205], v[204:205], v[206:207]
  v_pk_add_f32 v[192:193], v[192:193], v[196:197]
  v_pk_add_f32 v[200:201], v[200:201], v[204:205]
  v_pk_add_f32 v[192:193], v[192:193], v[200:201]
  v_cvt_pk_bf16_f32 v192, v192, v193
  ds_write_b32 v6, v192 offset:38912
  s_waitcnt lgkmcnt(0)
  ds_read_b128 v[12:15], v7 offset:38912
  s_waitcnt lgkmcnt(0)
  s_add_u32 s100, s11, 3
  s_and_b32 s100, s100, 15
  s_lshl_b32 s100, s100, 15
  s_add_u32 s100, s100, s7
  v_dot2_f32_bf16 v24, v48, v12, 0
  v_dot2_f32_bf16 v25, v52, v12, 0
  v_dot2_f32_bf16 v26, v56, v12, 0
  v_dot2_f32_bf16 v27, v60, v12, 0
  v_dot2_f32_bf16 v24, v49, v13, v24
  v_dot2_f32_bf16 v25, v53, v13, v25
  v_dot2_f32_bf16 v26, v57, v13, v26
  v_dot2_f32_bf16 v27, v61, v13, v27
  v_dot2_f32_bf16 v24, v50, v14, v24
  v_dot2_f32_bf16 v25, v54, v14, v25
  v_dot2_f32_bf16 v26, v58, v14, v26
  v_dot2_f32_bf16 v27, v62, v14, v27
  v_dot2_f32_bf16 v24, v51, v15, v24
  v_dot2_f32_bf16 v25, v55, v15, v25
  v_dot2_f32_bf16 v26, v59, v15, v26
  v_dot2_f32_bf16 v27, v63, v15, v27
  buffer_load_dwordx4 v[48:51], v4, s[40:43], s100 offen offset:0 nt
  buffer_load_dwordx4 v[52:55], v4, s[40:43], s100 offen offset:1024 nt
  buffer_load_dwordx4 v[56:59], v4, s[40:43], s100 offen offset:2048 nt
  buffer_load_dwordx4 v[60:63], v4, s[40:43], s100 offen offset:3072 nt
  v_add_f32_dpp v30, v24, v24 row_ror:8 row_mask:0xf bank_mask:0x3
  s_nop 1
  v_add_f32_dpp v30, v25, v25 row_ror:8 row_mask:0xf bank_mask:0xc
  v_add_f32_dpp v31, v26, v26 row_ror:8 row_mask:0xf bank_mask:0x3
  s_nop 1
  v_add_f32_dpp v31, v27, v27 row_ror:8 row_mask:0xf bank_mask:0xc
  v_add_f32_dpp v32, v30, v30 row_shl:4 row_mask:0xf bank_mask:0x5
  s_nop 1
  v_add_f32_dpp v32, v31, v31 row_shr:4 row_mask:0xf bank_mask:0xa
  s_nop 1
  v_add_f32_dpp v32, v32, v32 quad_perm:[1,0,3,2] row_mask:0xf bank_mask:0xf
  s_nop 1
  v_add_f32_dpp v32, v32, v32 quad_perm:[2,3,0,1] row_mask:0xf bank_mask:0xf
  v_cvt_pk_bf16_f32 v32, v32, v32
  v_and_b32 v32, 0xffff0000, v32
  v_mul_f32 v32, 0x3db504f3, v32
  v_cvt_pk_bf16_f32 v32, v32, v32
  v_and_b32 v32, 0xffff0000, v32
  s_nop 1
  v_max_f32_dpp v33, v32, v32 row_ror:4 row_mask:0xf bank_mask:0xf
  s_nop 1
  v_max_f32_dpp v33, v33, v33 row_ror:8 row_mask:0xf bank_mask:0xf
  v_max_f32 v33, v33, v28
  v_cmp_gt_f32 vcc, v33, v28
  s_cbranch_vccz L_skip_5
  v_sub_f32 v37, v28, v33
  v_mul_f32 v37, 0x3fb8aa3b, v37
  v_exp_f32 v37, v37
  v_mov_b32 v28, v33
  v_mul_f32 v16, v16, v37
  v_mul_f32 v17, v17, v37
  v_mul_f32 v18, v18, v37
  v_mul_f32 v19, v19, v37
  v_mul_f32 v20, v20, v37
  v_mul_f32 v21, v21, v37
  v_mul_f32 v22, v22, v37
  v_mul_f32 v23, v23, v37
  v_mul_f32 v29, v29, v37
L_skip_5:
  v_sub_f32 v34, v32, v28
  v_mul_f32 v34, 0x3fb8aa3b, v34
  v_exp_f32 v34, v34
  s_nop 0
  v_cvt_pk_bf16_f32 v35, v34, 0
  v_cvt_pk_bf16_f32 v36, 0, v34
  v_add_f32 v29, v29, v36
  v_dot2c_f32_bf16_dpp v16, v35, v80 row_newbcast:0 row_mask:0xf bank_mask:0xf
  v_dot2c_f32_bf16_dpp v17, v36, v80 row_newbcast:0 row_mask:0xf bank_mask:0xf
  v_dot2c_f32_bf16_dpp v18, v35, v81 row_newbcast:0 row_mask:0xf bank_mask:0xf
  v_dot2c_f32_bf16_dpp v19, v36, v81 row_newbcast:0 row_mask:0xf bank_mask:0xf
  v_dot2c_f32_bf16_dpp v20, v35, v82 row_newbcast:0 row_mask:0xf bank_mask:0xf
  v_dot2c_f32_bf16_dpp v21, v36, v82 row_newbcast:0 row_mask:0xf bank_mask:0xf
  v_dot2c_f32_bf16_dpp v22, v35, v83 row_newbcast:0 row_mask:0xf bank_mask:0xf
  v_dot2c_f32_bf16_dpp v23, v36, v83 row_newbcast:0 row_mask:0xf bank_mask:0xf
  v_dot2c_f32_bf16_dpp v16, v35, v84 row_newbcast:8 row_mask:0xf bank_mask:0xf
  v_dot2c_f32_bf16_dpp v17, v36, v84 row_newbcast:8 row_mask:0xf bank_mask:0xf
  v_dot2c_f32_bf16_dpp v18, v35, v85 row_newbcast:8 row_mask:0xf bank_mask:0xf
  v_dot2c_f32_bf16_dpp v19, v36, v85 row_newbcast:8 row_mask:0xf bank_mask:0xf
  v_dot2c_f32_bf16_dpp v20, v35, v86 row_newbcast:8 row_mask:0xf bank_mask:0xf
  v_dot2c_f32_bf16_dpp v21, v36, v86 row_newbcast:8 row_mask:0xf bank_mask:0xf
  v_dot2c_f32_bf16_dpp v22, v35, v87 row_newbcast:8 row_mask:0xf bank_mask:0xf
  v_dot2c_f32_bf16_dpp v23, v36, v87 row_newbcast:8 row_mask:0xf bank_mask:0xf
  v_dot2c_f32_bf16_dpp v16, v35, v88 row_newbcast:4 row_mask:0xf bank_mask:0xf
  v_dot2c_f32_bf16_dpp v17, v36, v88 row_newbcast:4 row_mask:0xf bank_mask:0xf
  v_dot2c_f32_bf16_dpp v18, v35, v89 row_newbcast:4 row_mask:0xf bank_mask:0xf
  v_dot2c_f32_bf16_dpp v19, v36, v89 row_newbcast:4 row_mask:0xf bank_mask:0xf
  v_dot2c_f32_bf16_dpp v20, v35, v90 row_newbcast:4 row_mask:0xf bank_mask:0xf
  v_dot2c_f32_bf16_dpp v21, v36, v90 row_newbcast:4 row_mask:0xf bank_mask:0xf
  v_dot2c_f32_bf16_dpp v22, v35, v91 row_newbcast:4 row_mask:0xf bank_mask:0xf
  v_dot2c_f32_bf16_dpp v23, v36, v91 row_newbcast:4 row_mask:0xf bank_mask:0xf
  v_dot2c_f32_bf16_dpp v16, v35, v92 row_newbcast:12 row_mask:0xf bank_mask:0xf
  v_dot2c_f32_bf16_dpp v17, v36, v92 row_newbcast:12 row_mask:0xf bank_mask:0xf
  v_dot2c_f32_bf16_dpp v18, v35, v93 row_newbcast:12 row_mask:0xf bank_mask:0xf
  v_dot2c_f32_bf16_dpp v19, v36, v93 row_newbcast:12 row_mask:0xf bank_mask:0xf
  v_dot2c_f32_bf16_dpp v20, v35, v94 row_newbcast:12 row_mask:0xf bank_mask:0xf
  v_dot2c_f32_bf16_dpp v21, v36, v94 row_newbcast:12 row_mask:0xf bank_mask:0xf
  v_dot2c_f32_bf16_dpp v22, v35, v95 row_newbcast:12 row_mask:0xf bank_mask:0xf
  v_dot2c_f32_bf16_dpp v23, v36, v95 row_newbcast:12 row_mask:0xf bank_mask:0xf
  buffer_load_dwordx4 v[80:83], v4, s[44:47], s100 offen offset:0 nt
  buffer_load_dwordx4 v[84:87], v4, s[44:47], s100 offen offset:1024 nt
  buffer_load_dwordx4 v[88:91], v4, s[44:47], s100 offen offset:2048 nt
  buffer_load_dwordx4 v[92:95], v4, s[44:47], s100 offen offset:3072 nt
  s_add_u32 s100, s11, 4
  s_and_b32 s100, s100, 15
  s_lshl_b32 s100, s100, 15
  s_add_u32 s100, s100, s7
  v_dot2_f32_bf16 v24, v64, v12, 0
  v_dot2_f32_bf16 v25, v68, v12, 0
  v_dot2_f32_bf16 v26, v72, v12, 0
  v_dot2_f32_bf16 v27, v76, v12, 0
  v_dot2_f32_bf16 v24, v65, v13, v24
  v_dot2_f32_bf16 v25, v69, v13, v25
  v_dot2_f32_bf16 v26, v73, v13, v26
  v_dot2_f32_bf16 v27, v77, v13, v27
  v_dot2_f32_bf16 v24, v66, v14, v24
  v_dot2_f32_bf16 v25, v70, v14, v25
  v_dot2_f32_bf16 v26, v74, v14, v26
  v_dot2_f32_bf16 v27, v78, v14, v27
  v_dot2_f32_bf16 v24, v67, v15, v24
  v_dot2_f32_bf16 v25, v71, v15, v25
  v_dot2_f32_bf16 v26, v75, v15, v26
  v_dot2_f32_bf16 v27, v79, v15, v27
  buffer_load_dwordx4 v[64:67], v4, s[40:43], s100 offen offset:0 nt
  buffer_load_dwordx4 v[68:71], v4, s[40:43], s100 offen offset:1024 nt
  buffer_load_dwordx4 v[72:75], v4, s[40:43], s100 offen offset:2048 nt
  buffer_load_dwordx4 v[76:79], v4, s[40:43], s100 offen offset:3072 nt
  v_add_f32_dpp v30, v24, v24 row_ror:8 row_mask:0xf bank_mask:0x3
  s_nop 1
  v_add_f32_dpp v30, v25, v25 row_ror:8 row_mask:0xf bank_mask:0xc
  v_add_f32_dpp v31, v26, v26 row_ror:8 row_mask:0xf bank_mask:0x3
  s_nop 1
  v_add_f32_dpp v31, v27, v27 row_ror:8 row_mask:0xf bank_mask:0xc
  v_add_f32_dpp v32, v30, v30 row_shl:4 row_mask:0xf bank_mask:0x5
  s_nop 1
  v_add_f32_dpp v32, v31, v31 row_shr:4 row_mask:0xf bank_mask:0xa
  s_nop 1
  v_add_f32_dpp v32, v32, v32 quad_perm:[1,0,3,2] row_mask:0xf bank_mask:0xf
  s_nop 1
  v_add_f32_dpp v32, v32, v32 quad_perm:[2,3,0,1] row_mask:0xf bank_mask:0xf
  v_cvt_pk_bf16_f32 v32, v32, v32
  v_and_b32 v32, 0xffff0000, v32
  v_mul_f32 v32, 0x3db504f3, v32
  v_cvt_pk_bf16_f32 v32, v32, v32
  v_and_b32 v32, 0xffff0000, v32
  s_nop 1
  v_max_f32_dpp v33, v32, v32 row_ror:4 row_mask:0xf bank_mask:0xf
  s_nop 1
  v_max_f32_dpp v33, v33, v33 row_ror:8 row_mask:0xf bank_mask:0xf
  v_max_f32 v33, v33, v28
  v_cmp_gt_f32 vcc, v33, v28
  s_cbranch_vccz L_skip_6
  v_sub_f32 v37, v28, v33
  v_mul_f32 v37, 0x3fb8aa3b, v37
  v_exp_f32 v37, v37
  v_mov_b32 v28, v33
  v_mul_f32 v16, v16, v37
  v_mul_f32 v17, v17, v37
  v_mul_f32 v18, v18, v37
  v_mul_f32 v19, v19, v37
  v_mul_f32 v20, v20, v37
  v_mul_f32 v21, v21, v37
  v_mul_f32 v22, v22, v37
  v_mul_f32 v23, v23, v37
  v_mul_f32 v29, v29, v37
L_skip_6:
  v_sub_f32 v34, v32, v28
  v_mul_f32 v34, 0x3fb8aa3b, v34
  v_exp_f32 v34, v34
  s_nop 0
  v_cvt_pk_bf16_f32 v35, v34, 0
  v_cvt_pk_bf16_f32 v36, 0, v34
  v_add_f32 v29, v29, v36
  s_waitcnt vmcnt(20)
  v_dot2c_f32_bf16_dpp v16, v35, v96 row_newbcast:0 row_mask:0xf bank_mask:0xf
  v_dot2c_f32_bf16_dpp v17, v36, v96 row_newbcast:0 row_mask:0xf bank_mask:0xf
  v_dot2c_f32_bf16_dpp v18, v35, v97 row_newbcast:0 row_mask:0xf bank_mask:0xf
  v_dot2c_f32_bf16_dpp v19, v36, v97 row_newbcast:0 row_mask:0xf bank_mask:0xf
  v_dot2c_f32_bf16_dpp v20, v35, v98 row_newbcast:0 row_mask:0xf bank_mask:0xf
  v_dot2c_f32_bf16_dpp v21, v36, v98 row_newbcast:0 row_mask:0xf bank_mask:0xf
  v_dot2c_f32_bf16_dpp v22, v35, v99 row_newbcast:0 row_mask:0xf bank_mask:0xf
  v_dot2c_f32_bf16_dpp v23, v36, v99 row_newbcast:0 row_mask:0xf bank_mask:0xf
  v_dot2c_f32_bf16_dpp v16, v35, v100 row_newbcast:8 row_mask:0xf bank_mask:0xf
  v_dot2c_f32_bf16_dpp v17, v36, v100 row_newbcast:8 row_mask:0xf bank_mask:0xf
  v_dot2c_f32_bf16_dpp v18, v35, v101 row_newbcast:8 row_mask:0xf bank_mask:0xf
  v_dot2c_f32_bf16_dpp v19, v36, v101 row_newbcast:8 row_mask:0xf bank_mask:0xf
  v_dot2c_f32_bf16_dpp v20, v35, v102 row_newbcast:8 row_mask:0xf bank_mask:0xf
  v_dot2c_f32_bf16_dpp v21, v36, v102 row_newbcast:8 row_mask:0xf bank_mask:0xf
  v_dot2c_f32_bf16_dpp v22, v35, v103 row_newbcast:8 row_mask:0xf bank_mask:0xf
  v_dot2c_f32_bf16_dpp v23, v36, v103 row_newbcast:8 row_mask:0xf bank_mask:0xf
  v_dot2c_f32_bf16_dpp v16, v35, v104 row_newbcast:4 row_mask:0xf bank_mask:0xf
  v_dot2c_f32_bf16_dpp v17, v36, v104 row_newbcast:4 row_mask:0xf bank_mask:0xf
  v_dot2c_f32_bf16_dpp v18, v35, v105 row_newbcast:4 row_mask:0xf bank_mask:0xf
  v_dot2c_f32_bf16_dpp v19, v36, v105 row_newbcast:4 row_mask:0xf bank_mask:0xf
  v_dot2c_f32_bf16_dpp v20, v35, v106 row_newbcast:4 row_mask:0xf bank_mask:0xf
  v_dot2c_f32_bf16_dpp v21, v36, v106 row_newbcast:4 row_mask:0xf bank_mask:0xf
  v_dot2c_f32_bf16_dpp v22, v35, v107 row_newbcast:4 row_mask:0xf bank_mask:0xf
  v_dot2c_f32_bf16_dpp v23, v36, v107 row_newbcast:4 row_mask:0xf bank_mask:0xf
  v_dot2c_f32_bf16_dpp v16, v35, v108 row_newbcast:12 row_mask:0xf bank_mask:0xf
  v_dot2c_f32_bf16_dpp v17, v36, v108 row_newbcast:12 row_mask:0xf bank_mask:0xf
  v_dot2c_f32_bf16_dpp v18, v35, v109 row_newbcast:12 row_mask:0xf bank_mask:0xf
  v_dot2c_f32_bf16_dpp v19, v36, v109 row_newbcast:12 row_mask:0xf bank_mask:0xf
  v_dot2c_f32_bf16_dpp v20, v35, v110 row_newbcast:12 row_mask:0xf bank_mask:0xf
  v_dot2c_f32_bf16_dpp v21, v36, v110 row_newbcast:12 row_mask:0xf bank_mask:0xf
  v_dot2c_f32_bf16_dpp v22, v35, v111 row_newbcast:12 row_mask:0xf bank_mask:0xf
  v_dot2c_f32_bf16_dpp v23, v36, v111 row_newbcast:12 row_mask:0xf bank_mask:0xf
  buffer_load_dwordx4 v[96:99], v4, s[44:47], s100 offen offset:0 nt
  buffer_load_dwordx4 v[100:103], v4, s[44:47], s100 offen offset:1024 nt
  buffer_load_dwordx4 v[104:107], v4, s[44:47], s100 offen offset:2048 nt
  buffer_load_dwordx4 v[108:111], v4, s[44:47], s100 offen offset:3072 nt
  s_waitcnt vmcnt(20)
  v_dot2_f32_bf16 v24, v112, v12, 0
  v_dot2_f32_bf16 v25, v116, v12, 0
  v_dot2_f32_bf16 v26, v120, v12, 0
  v_dot2_f32_bf16 v27, v124, v12, 0
  v_dot2_f32_bf16 v24, v113, v13, v24
  v_dot2_f32_bf16 v25, v117, v13, v25
  v_dot2_f32_bf16 v26, v121, v13, v26
  v_dot2_f32_bf16 v27, v125, v13, v27
  v_dot2_f32_bf16 v24, v114, v14, v24
  v_dot2_f32_bf16 v25, v118, v14, v25
  v_dot2_f32_bf16 v26, v122, v14, v26
  v_dot2_f32_bf16 v27, v126, v14, v27
  v_dot2_f32_bf16 v24, v115, v15, v24
  v_dot2_f32_bf16 v25, v119, v15, v25
  v_dot2_f32_bf16 v26, v123, v15, v26
  v_dot2_f32_bf16 v27, v127, v15, v27
  v_add_f32_dpp v30, v24, v24 row_ror:8 row_mask:0xf bank_mask:0x3
  s_nop 1
  v_add_f32_dpp v30, v25, v25 row_ror:8 row_mask:0xf bank_mask:0xc
  v_add_f32_dpp v31, v26, v26 row_ror:8 row_mask:0xf bank_mask:0x3
  s_nop 1
  v_add_f32_dpp v31, v27, v27 row_ror:8 row_mask:0xf bank_mask:0xc
  v_add_f32_dpp v32, v30, v30 row_shl:4 row_mask:0xf bank_mask:0x5
  s_nop 1
  v_add_f32_dpp v32, v31, v31 row_shr:4 row_mask:0xf bank_mask:0xa
  s_nop 1
  v_add_f32_dpp v32, v32, v32 quad_perm:[1,0,3,2] row_mask:0xf bank_mask:0xf
  s_nop 1
  v_add_f32_dpp v32, v32, v32 quad_perm:[2,3,0,1] row_mask:0xf bank_mask:0xf
  v_cvt_pk_bf16_f32 v32, v32, v32
  v_and_b32 v32, 0xffff0000, v32
  v_mul_f32 v32, 0x3db504f3, v32
  v_cvt_pk_bf16_f32 v32, v32, v32
  v_and_b32 v32, 0xffff0000, v32
  s_nop 1
  v_max_f32_dpp v33, v32, v32 row_ror:4 row_mask:0xf bank_mask:0xf
  s_nop 1
  v_max_f32_dpp v33, v33, v33 row_ror:8 row_mask:0xf bank_mask:0xf
  v_max_f32 v33, v33, v28
  v_cmp_gt_f32 vcc, v33, v28
  s_cbranch_vccz L_skip_7
  v_sub_f32 v37, v28, v33
  v_mul_f32 v37, 0x3fb8aa3b, v37
  v_exp_f32 v37, v37
  v_mov_b32 v28, v33
  v_mul_f32 v16, v16, v37
  v_mul_f32 v17, v17, v37
  v_mul_f32 v18, v18, v37
  v_mul_f32 v19, v19, v37
  v_mul_f32 v20, v20, v37
  v_mul_f32 v21, v21, v37
  v_mul_f32 v22, v22, v37
  v_mul_f32 v23, v23, v37
  v_mul_f32 v29, v29, v37
L_skip_7:
  v_sub_f32 v34, v32, v28
  v_mul_f32 v34, 0x3fb8aa3b, v34
  v_exp_f32 v34, v34
  s_nop 0
  v_cvt_pk_bf16_f32 v35, v34, 0
  v_cvt_pk_bf16_f32 v36, 0, v34
  v_add_f32 v29, v29, v36
  s_waitcnt vmcnt(16)
  v_dot2c_f32_bf16_dpp v16, v35, v128 row_newbcast:0 row_mask:0xf bank_mask:0xf
  v_dot2c_f32_bf16_dpp v17, v36, v128 row_newbcast:0 row_mask:0xf bank_mask:0xf
  v_dot2c_f32_bf16_dpp v18, v35, v129 row_newbcast:0 row_mask:0xf bank_mask:0xf
  v_dot2c_f32_bf16_dpp v19, v36, v129 row_newbcast:0 row_mask:0xf bank_mask:0xf
  v_dot2c_f32_bf16_dpp v20, v35, v130 row_newbcast:0 row_mask:0xf bank_mask:0xf
  v_dot2c_f32_bf16_dpp v21, v36, v130 row_newbcast:0 row_mask:0xf bank_mask:0xf
  v_dot2c_f32_bf16_dpp v22, v35, v131 row_newbcast:0 row_mask:0xf bank_mask:0xf
  v_dot2c_f32_bf16_dpp v23, v36, v131 row_newbcast:0 row_mask:0xf bank_mask:0xf
  v_dot2c_f32_bf16_dpp v16, v35, v132 row_newbcast:8 row_mask:0xf bank_mask:0xf
  v_dot2c_f32_bf16_dpp v17, v36, v132 row_newbcast:8 row_mask:0xf bank_mask:0xf
  v_dot2c_f32_bf16_dpp v18, v35, v133 row_newbcast:8 row_mask:0xf bank_mask:0xf
  v_dot2c_f32_bf16_dpp v19, v36, v133 row_newbcast:8 row_mask:0xf bank_mask:0xf
  v_dot2c_f32_bf16_dpp v20, v35, v134 row_newbcast:8 row_mask:0xf bank_mask:0xf
  v_dot2c_f32_bf16_dpp v21, v36, v134 row_newbcast:8 row_mask:0xf bank_mask:0xf
  v_dot2c_f32_bf16_dpp v22, v35, v135 row_newbcast:8 row_mask:0xf bank_mask:0xf
  v_dot2c_f32_bf16_dpp v23, v36, v135 row_newbcast:8 row_mask:0xf bank_mask:0xf
  v_dot2c_f32_bf16_dpp v16, v35, v136 row_newbcast:4 row_mask:0xf bank_mask:0xf
  v_dot2c_f32_bf16_dpp v17, v36, v136 row_newbcast:4 row_mask:0xf bank_mask:0xf
  v_dot2c_f32_bf16_dpp v18, v35, v137 row_newbcast:4 row_mask:0xf bank_mask:0xf
  v_dot2c_f32_bf16_dpp v19, v36, v137 row_newbcast:4 row_mask:0xf bank_mask:0xf
  v_dot2c_f32_bf16_dpp v20, v35, v138 row_newbcast:4 row_mask:0xf bank_mask:0xf
  v_dot2c_f32_bf16_dpp v21, v36, v138 row_newbcast:4 row_mask:0xf bank_mask:0xf
  v_dot2c_f32_bf16_dpp v22, v35, v139 row_newbcast:4 row_mask:0xf bank_mask:0xf
  v_dot2c_f32_bf16_dpp v23, v36, v139 row_newbcast:4 row_mask:0xf bank_mask:0xf
  v_dot2c_f32_bf16_dpp v16, v35, v140 row_newbcast:12 row_mask:0xf bank_mask:0xf
  v_dot2c_f32_bf16_dpp v17, v36, v140 row_newbcast:12 row_mask:0xf bank_mask:0xf
  v_dot2c_f32_bf16_dpp v18, v35, v141 row_newbcast:12 row_mask:0xf bank_mask:0xf
  v_dot2c_f32_bf16_dpp v19, v36, v141 row_newbcast:12 row_mask:0xf bank_mask:0xf
  v_dot2c_f32_bf16_dpp v20, v35, v142 row_newbcast:12 row_mask:0xf bank_mask:0xf
  v_dot2c_f32_bf16_dpp v21, v36, v142 row_newbcast:12 row_mask:0xf bank_mask:0xf
  v_dot2c_f32_bf16_dpp v22, v35, v143 row_newbcast:12 row_mask:0xf bank_mask:0xf
  v_dot2c_f32_bf16_dpp v23, v36, v143 row_newbcast:12 row_mask:0xf bank_mask:0xf
  s_waitcnt vmcnt(12)
  s_add_u32 s100, s11, 5
  s_and_b32 s100, s100, 15
  s_lshl_b32 s100, s100, 15
  s_add_u32 s100, s100, s7
  v_dot2_f32_bf16 v24, v48, v12, 0
  v_dot2_f32_bf16 v25, v52, v12, 0
  v_dot2_f32_bf16 v26, v56, v12, 0
  v_dot2_f32_bf16 v27, v60, v12, 0
  v_dot2_f32_bf16 v24, v49, v13, v24
  v_dot2_f32_bf16 v25, v53, v13, v25
  v_dot2_f32_bf16 v26, v57, v13, v26
  v_dot2_f32_bf16 v27, v61, v13, v27
  v_dot2_f32_bf16 v24, v50, v14, v24
  v_dot2_f32_bf16 v25, v54, v14, v25
  v_dot2_f32_bf16 v26, v58, v14, v26
  v_dot2_f32_bf16 v27, v62, v14, v27
  v_dot2_f32_bf16 v24, v51, v15, v24
  v_dot2_f32_bf16 v25, v55, v15, v25
  v_dot2_f32_bf16 v26, v59, v15, v26
  v_dot2_f32_bf16 v27, v63, v15, v27
  buffer_load_dwordx4 v[48:51], v4, s[40:43], s100 offen offset:0 nt
  buffer_load_dwordx4 v[52:55], v4, s[40:43], s100 offen offset:1024 nt
  buffer_load_dwordx4 v[56:59], v4, s[40:43], s100 offen offset:2048 nt
  buffer_load_dwordx4 v[60:63], v4, s[40:43], s100 offen offset:3072 nt
  v_add_f32_dpp v30, v24, v24 row_ror:8 row_mask:0xf bank_mask:0x3
  s_nop 1
  v_add_f32_dpp v30, v25, v25 row_ror:8 row_mask:0xf bank_mask:0xc
  v_add_f32_dpp v31, v26, v26 row_ror:8 row_mask:0xf bank_mask:0x3
  s_nop 1
  v_add_f32_dpp v31, v27, v27 row_ror:8 row_mask:0xf bank_mask:0xc
  v_add_f32_dpp v32, v30, v30 row_shl:4 row_mask:0xf bank_mask:0x5
  s_nop 1
  v_add_f32_dpp v32, v31, v31 row_shr:4 row_mask:0xf bank_mask:0xa
  s_nop 1
  v_add_f32_dpp v32, v32, v32 quad_perm:[1,0,3,2] row_mask:0xf bank_mask:0xf
  s_nop 1
  v_add_f32_dpp v32, v32, v32 quad_perm:[2,3,0,1] row_mask:0xf bank_mask:0xf
  v_cvt_pk_bf16_f32 v32, v32, v32
  v_and_b32 v32, 0xffff0000, v32
  v_mul_f32 v32, 0x3db504f3, v32
  v_cvt_pk_bf16_f32 v32, v32, v32
  v_and_b32 v32, 0xffff0000, v32
  s_nop 1
  v_max_f32_dpp v33, v32, v32 row_ror:4 row_mask:0xf bank_mask:0xf
  s_nop 1
  v_max_f32_dpp v33, v33, v33 row_ror:8 row_mask:0xf bank_mask:0xf
  v_max_f32 v33, v33, v28
  v_cmp_gt_f32 vcc, v33, v28
  s_cbranch_vccz L_skip_8
  v_sub_f32 v37, v28, v33
  v_mul_f32 v37, 0x3fb8aa3b, v37
  v_exp_f32 v37, v37
  v_mov_b32 v28, v33
  v_mul_f32 v16, v16, v37
  v_mul_f32 v17, v17, v37
  v_mul_f32 v18, v18, v37
  v_mul_f32 v19, v19, v37
  v_mul_f32 v20, v20, v37
  v_mul_f32 v21, v21, v37
  v_mul_f32 v22, v22, v37
  v_mul_f32 v23, v23, v37
  v_mul_f32 v29, v29, v37
L_skip_8:
  v_sub_f32 v34, v32, v28
  v_mul_f32 v34, 0x3fb8aa3b, v34
  v_exp_f32 v34, v34
  s_nop 0
  v_cvt_pk_bf16_f32 v35, v34, 0
  v_cvt_pk_bf16_f32 v36, 0, v34
  v_add_f32 v29, v29, v36
  s_waitcnt vmcnt(12)
  v_dot2c_f32_bf16_dpp v16, v35, v80 row_newbcast:0 row_mask:0xf bank_mask:0xf
  v_dot2c_f32_bf16_dpp v17, v36, v80 row_newbcast:0 row_mask:0xf bank_mask:0xf
  v_dot2c_f32_bf16_dpp v18, v35, v81 row_newbcast:0 row_mask:0xf bank_mask:0xf
  v_dot2c_f32_bf16_dpp v19, v36, v81 row_newbcast:0 row_mask:0xf bank_mask:0xf
  v_dot2c_f32_bf16_dpp v20, v35, v82 row_newbcast:0 row_mask:0xf bank_mask:0xf
  v_dot2c_f32_bf16_dpp v21, v36, v82 row_newbcast:0 row_mask:0xf bank_mask:0xf
  v_dot2c_f32_bf16_dpp v22, v35, v83 row_newbcast:0 row_mask:0xf bank_mask:0xf
  v_dot2c_f32_bf16_dpp v23, v36, v83 row_newbcast:0 row_mask:0xf bank_mask:0xf
  v_dot2c_f32_bf16_dpp v16, v35, v84 row_newbcast:8 row_mask:0xf bank_mask:0xf
  v_dot2c_f32_bf16_dpp v17, v36, v84 row_newbcast:8 row_mask:0xf bank_mask:0xf
  v_dot2c_f32_bf16_dpp v18, v35, v85 row_newbcast:8 row_mask:0xf bank_mask:0xf
  v_dot2c_f32_bf16_dpp v19, v36, v85 row_newbcast:8 row_mask:0xf bank_mask:0xf
  v_dot2c_f32_bf16_dpp v20, v35, v86 row_newbcast:8 row_mask:0xf bank_mask:0xf
  v_dot2c_f32_bf16_dpp v21, v36, v86 row_newbcast:8 row_mask:0xf bank_mask:0xf
  v_dot2c_f32_bf16_dpp v22, v35, v87 row_newbcast:8 row_mask:0xf bank_mask:0xf
  v_dot2c_f32_bf16_dpp v23, v36, v87 row_newbcast:8 row_mask:0xf bank_mask:0xf
  v_dot2c_f32_bf16_dpp v16, v35, v88 row_newbcast:4 row_mask:0xf bank_mask:0xf
  v_dot2c_f32_bf16_dpp v17, v36, v88 row_newbcast:4 row_mask:0xf bank_mask:0xf
  v_dot2c_f32_bf16_dpp v18, v35, v89 row_newbcast:4 row_mask:0xf bank_mask:0xf
  v_dot2c_f32_bf16_dpp v19, v36, v89 row_newbcast:4 row_mask:0xf bank_mask:0xf
  v_dot2c_f32_bf16_dpp v20, v35, v90 row_newbcast:4 row_mask:0xf bank_mask:0xf
  v_dot2c_f32_bf16_dpp v21, v36, v90 row_newbcast:4 row_mask:0xf bank_mask:0xf
  v_dot2c_f32_bf16_dpp v22, v35, v91 row_newbcast:4 row_mask:0xf bank_mask:0xf
  v_dot2c_f32_bf16_dpp v23, v36, v91 row_newbcast:4 row_mask:0xf bank_mask:0xf
  v_dot2c_f32_bf16_dpp v16, v35, v92 row_newbcast:12 row_mask:0xf bank_mask:0xf
  v_dot2c_f32_bf16_dpp v17, v36, v92 row_newbcast:12 row_mask:0xf bank_mask:0xf
  v_dot2c_f32_bf16_dpp v18, v35, v93 row_newbcast:12 row_mask:0xf bank_mask:0xf
  v_dot2c_f32_bf16_dpp v19, v36, v93 row_newbcast:12 row_mask:0xf bank_mask:0xf
  v_dot2c_f32_bf16_dpp v20, v35, v94 row_newbcast:12 row_mask:0xf bank_mask:0xf
  v_dot2c_f32_bf16_dpp v21, v36, v94 row_newbcast:12 row_mask:0xf bank_mask:0xf
  v_dot2c_f32_bf16_dpp v22, v35, v95 row_newbcast:12 row_mask:0xf bank_mask:0xf
  v_dot2c_f32_bf16_dpp v23, v36, v95 row_newbcast:12 row_mask:0xf bank_mask:0xf
  buffer_load_dwordx4 v[80:83], v4, s[44:47], s100 offen offset:0 nt
  buffer_load_dwordx4 v[84:87], v4, s[44:47], s100 offen offset:1024 nt
  buffer_load_dwordx4 v[88:91], v4, s[44:47], s100 offen offset:2048 nt
  buffer_load_dwordx4 v[92:95], v4, s[44:47], s100 offen offset:3072 nt
  s_waitcnt vmcnt(12)
  s_add_u32 s100, s11, 6
  s_and_b32 s100, s100, 15
  s_lshl_b32 s100, s100, 15
  s_add_u32 s100, s100, s7
  v_dot2_f32_bf16 v24, v64, v12, 0
  v_dot2_f32_bf16 v25, v68, v12, 0
  v_dot2_f32_bf16 v26, v72, v12, 0
  v_dot2_f32_bf16 v27, v76, v12, 0
  v_dot2_f32_bf16 v24, v65, v13, v24
  v_dot2_f32_bf16 v25, v69, v13, v25
  v_dot2_f32_bf16 v26, v73, v13, v26
  v_dot2_f32_bf16 v27, v77, v13, v27
  v_dot2_f32_bf16 v24, v66, v14, v24
  v_dot2_f32_bf16 v25, v70, v14, v25
  v_dot2_f32_bf16 v26, v74, v14, v26
  v_dot2_f32_bf16 v27, v78, v14, v27
  v_dot2_f32_bf16 v24, v67, v15, v24
  v_dot2_f32_bf16 v25, v71, v15, v25
  v_dot2_f32_bf16 v26, v75, v15, v26
  v_dot2_f32_bf16 v27, v79, v15, v27
  buffer_load_dwordx4 v[64:67], v4, s[40:43], s100 offen offset:0 nt
  buffer_load_dwordx4 v[68:71], v4, s[40:43], s100 offen offset:1024 nt
  buffer_load_dwordx4 v[72:75], v4, s[40:43], s100 offen offset:2048 nt
  buffer_load_dwordx4 v[76:79], v4, s[40:43], s100 offen offset:3072 nt
  v_add_f32_dpp v30, v24, v24 row_ror:8 row_mask:0xf bank_mask:0x3
  s_nop 1
  v_add_f32_dpp v30, v25, v25 row_ror:8 row_mask:0xf bank_mask:0xc
  v_add_f32_dpp v31, v26, v26 row_ror:8 row_mask:0xf bank_mask:0x3
  s_nop 1
  v_add_f32_dpp v31, v27, v27 row_ror:8 row_mask:0xf bank_mask:0xc
  v_add_f32_dpp v32, v30, v30 row_shl:4 row_mask:0xf bank_mask:0x5
  s_nop 1
  v_add_f32_dpp v32, v31, v31 row_shr:4 row_mask:0xf bank_mask:0xa
  s_nop 1
  v_add_f32_dpp v32, v32, v32 quad_perm:[1,0,3,2] row_mask:0xf bank_mask:0xf
  s_nop 1
  v_add_f32_dpp v32, v32, v32 quad_perm:[2,3,0,1] row_mask:0xf bank_mask:0xf
  v_cvt_pk_bf16_f32 v32, v32, v32
  v_and_b32 v32, 0xffff0000, v32
  v_mul_f32 v32, 0x3db504f3, v32
  v_cvt_pk_bf16_f32 v32, v32, v32
  v_and_b32 v32, 0xffff0000, v32
  s_nop 1
  v_max_f32_dpp v33, v32, v32 row_ror:4 row_mask:0xf bank_mask:0xf
  s_nop 1
  v_max_f32_dpp v33, v33, v33 row_ror:8 row_mask:0xf bank_mask:0xf
  v_max_f32 v33, v33, v28
  v_cmp_gt_f32 vcc, v33, v28
  s_cbranch_vccz L_skip_9
  v_sub_f32 v37, v28, v33
  v_mul_f32 v37, 0x3fb8aa3b, v37
  v_exp_f32 v37, v37
  v_mov_b32 v28, v33
  v_mul_f32 v16, v16, v37
  v_mul_f32 v17, v17, v37
  v_mul_f32 v18, v18, v37
  v_mul_f32 v19, v19, v37
  v_mul_f32 v20, v20, v37
  v_mul_f32 v21, v21, v37
  v_mul_f32 v22, v22, v37
  v_mul_f32 v23, v23, v37
  v_mul_f32 v29, v29, v37
L_skip_9:
  v_sub_f32 v34, v32, v28
  v_mul_f32 v34, 0x3fb8aa3b, v34
  v_exp_f32 v34, v34
  s_nop 0
  v_cvt_pk_bf16_f32 v35, v34, 0
  v_cvt_pk_bf16_f32 v36, 0, v34
  v_add_f32 v29, v29, v36
  s_waitcnt vmcnt(12)
  v_dot2c_f32_bf16_dpp v16, v35, v96 row_newbcast:0 row_mask:0xf bank_mask:0xf
  v_dot2c_f32_bf16_dpp v17, v36, v96 row_newbcast:0 row_mask:0xf bank_mask:0xf
  v_dot2c_f32_bf16_dpp v18, v35, v97 row_newbcast:0 row_mask:0xf bank_mask:0xf
  v_dot2c_f32_bf16_dpp v19, v36, v97 row_newbcast:0 row_mask:0xf bank_mask:0xf
  v_dot2c_f32_bf16_dpp v20, v35, v98 row_newbcast:0 row_mask:0xf bank_mask:0xf
  v_dot2c_f32_bf16_dpp v21, v36, v98 row_newbcast:0 row_mask:0xf bank_mask:0xf
  v_dot2c_f32_bf16_dpp v22, v35, v99 row_newbcast:0 row_mask:0xf bank_mask:0xf
  v_dot2c_f32_bf16_dpp v23, v36, v99 row_newbcast:0 row_mask:0xf bank_mask:0xf
  v_dot2c_f32_bf16_dpp v16, v35, v100 row_newbcast:8 row_mask:0xf bank_mask:0xf
  v_dot2c_f32_bf16_dpp v17, v36, v100 row_newbcast:8 row_mask:0xf bank_mask:0xf
  v_dot2c_f32_bf16_dpp v18, v35, v101 row_newbcast:8 row_mask:0xf bank_mask:0xf
  v_dot2c_f32_bf16_dpp v19, v36, v101 row_newbcast:8 row_mask:0xf bank_mask:0xf
  v_dot2c_f32_bf16_dpp v20, v35, v102 row_newbcast:8 row_mask:0xf bank_mask:0xf
  v_dot2c_f32_bf16_dpp v21, v36, v102 row_newbcast:8 row_mask:0xf bank_mask:0xf
  v_dot2c_f32_bf16_dpp v22, v35, v103 row_newbcast:8 row_mask:0xf bank_mask:0xf
  v_dot2c_f32_bf16_dpp v23, v36, v103 row_newbcast:8 row_mask:0xf bank_mask:0xf
  v_dot2c_f32_bf16_dpp v16, v35, v104 row_newbcast:4 row_mask:0xf bank_mask:0xf
  v_dot2c_f32_bf16_dpp v17, v36, v104 row_newbcast:4 row_mask:0xf bank_mask:0xf
  v_dot2c_f32_bf16_dpp v18, v35, v105 row_newbcast:4 row_mask:0xf bank_mask:0xf
  v_dot2c_f32_bf16_dpp v19, v36, v105 row_newbcast:4 row_mask:0xf bank_mask:0xf
  v_dot2c_f32_bf16_dpp v20, v35, v106 row_newbcast:4 row_mask:0xf bank_mask:0xf
  v_dot2c_f32_bf16_dpp v21, v36, v106 row_newbcast:4 row_mask:0xf bank_mask:0xf
  v_dot2c_f32_bf16_dpp v22, v35, v107 row_newbcast:4 row_mask:0xf bank_mask:0xf
  v_dot2c_f32_bf16_dpp v23, v36, v107 row_newbcast:4 row_mask:0xf bank_mask:0xf
  v_dot2c_f32_bf16_dpp v16, v35, v108 row_newbcast:12 row_mask:0xf bank_mask:0xf
  v_dot2c_f32_bf16_dpp v17, v36, v108 row_newbcast:12 row_mask:0xf bank_mask:0xf
  v_dot2c_f32_bf16_dpp v18, v35, v109 row_newbcast:12 row_mask:0xf bank_mask:0xf
  v_dot2c_f32_bf16_dpp v19, v36, v109 row_newbcast:12 row_mask:0xf bank_mask:0xf
  v_dot2c_f32_bf16_dpp v20, v35, v110 row_newbcast:12 row_mask:0xf bank_mask:0xf
  v_dot2c_f32_bf16_dpp v21, v36, v110 row_newbcast:12 row_mask:0xf bank_mask:0xf
  v_dot2c_f32_bf16_dpp v22, v35, v111 row_newbcast:12 row_mask:0xf bank_mask:0xf
  v_dot2c_f32_bf16_dpp v23, v36, v111 row_newbcast:12 row_mask:0xf bank_mask:0xf
  buffer_load_dwordx4 v[96:99], v4, s[44:47], s100 offen offset:0 nt
  buffer_load_dwordx4 v[100:103], v4, s[44:47], s100 offen offset:1024 nt
  buffer_load_dwordx4 v[104:107], v4, s[44:47], s100 offen offset:2048 nt
  buffer_load_dwordx4 v[108:111], v4, s[44:47], s100 offen offset:3072 nt
  s_waitcnt vmcnt(12)
  s_add_u32 s100, s11, 7
  s_and_b32 s100, s100, 15
  s_lshl_b32 s100, s100, 15
  s_add_u32 s100, s100, s7
  v_dot2_f32_bf16 v24, v48, v12, 0
  v_dot2_f32_bf16 v25, v52, v12, 0
  v_dot2_f32_bf16 v26, v56, v12, 0
  v_dot2_f32_bf16 v27, v60, v12, 0
  v_dot2_f32_bf16 v24, v49, v13, v24
  v_dot2_f32_bf16 v25, v53, v13, v25
  v_dot2_f32_bf16 v26, v57, v13, v26
  v_dot2_f32_bf16 v27, v61, v13, v27
  v_dot2_f32_bf16 v24, v50, v14, v24
  v_dot2_f32_bf16 v25, v54, v14, v25
  v_dot2_f32_bf16 v26, v58, v14, v26
  v_dot2_f32_bf16 v27, v62, v14, v27
  v_dot2_f32_bf16 v24, v51, v15, v24
  v_dot2_f32_bf16 v25, v55, v15, v25
  v_dot2_f32_bf16 v26, v59, v15, v26
  v_dot2_f32_bf16 v27, v63, v15, v27
  buffer_load_dwordx4 v[48:51], v4, s[40:43], s100 offen offset:0 nt
  buffer_load_dwordx4 v[52:55], v4, s[40:43], s100 offen offset:1024 nt
  buffer_load_dwordx4 v[56:59], v4, s[40:43], s100 offen offset:2048 nt
  buffer_load_dwordx4 v[60:63], v4, s[40:43], s100 offen offset:3072 nt
  v_add_f32_dpp v30, v24, v24 row_ror:8 row_mask:0xf bank_mask:0x3
  s_nop 1
  v_add_f32_dpp v30, v25, v25 row_ror:8 row_mask:0xf bank_mask:0xc
  v_add_f32_dpp v31, v26, v26 row_ror:8 row_mask:0xf bank_mask:0x3
  s_nop 1
  v_add_f32_dpp v31, v27, v27 row_ror:8 row_mask:0xf bank_mask:0xc
  v_add_f32_dpp v32, v30, v30 row_shl:4 row_mask:0xf bank_mask:0x5
  s_nop 1
  v_add_f32_dpp v32, v31, v31 row_shr:4 row_mask:0xf bank_mask:0xa
  s_nop 1
  v_add_f32_dpp v32, v32, v32 quad_perm:[1,0,3,2] row_mask:0xf bank_mask:0xf
  s_nop 1
  v_add_f32_dpp v32, v32, v32 quad_perm:[2,3,0,1] row_mask:0xf bank_mask:0xf
  v_cvt_pk_bf16_f32 v32, v32, v32
  v_and_b32 v32, 0xffff0000, v32
  v_mul_f32 v32, 0x3db504f3, v32
  v_cvt_pk_bf16_f32 v32, v32, v32
  v_and_b32 v32, 0xffff0000, v32
  s_nop 1
  v_max_f32_dpp v33, v32, v32 row_ror:4 row_mask:0xf bank_mask:0xf
  s_nop 1
  v_max_f32_dpp v33, v33, v33 row_ror:8 row_mask:0xf bank_mask:0xf
  v_max_f32 v33, v33, v28
  v_cmp_gt_f32 vcc, v33, v28
  s_cbranch_vccz L_skip_10
  v_sub_f32 v37, v28, v33
  v_mul_f32 v37, 0x3fb8aa3b, v37
  v_exp_f32 v37, v37
  v_mov_b32 v28, v33
  v_mul_f32 v16, v16, v37
  v_mul_f32 v17, v17, v37
  v_mul_f32 v18, v18, v37
  v_mul_f32 v19, v19, v37
  v_mul_f32 v20, v20, v37
  v_mul_f32 v21, v21, v37
  v_mul_f32 v22, v22, v37
  v_mul_f32 v23, v23, v37
  v_mul_f32 v29, v29, v37
L_skip_10:
  v_sub_f32 v34, v32, v28
  v_mul_f32 v34, 0x3fb8aa3b, v34
  v_exp_f32 v34, v34
  s_nop 0
  v_cvt_pk_bf16_f32 v35, v34, 0
  v_cvt_pk_bf16_f32 v36, 0, v34
  v_add_f32 v29, v29, v36
  s_waitcnt vmcnt(12)
  v_dot2c_f32_bf16_dpp v16, v35, v80 row_newbcast:0 row_mask:0xf bank_mask:0xf
  v_dot2c_f32_bf16_dpp v17, v36, v80 row_newbcast:0 row_mask:0xf bank_mask:0xf
  v_dot2c_f32_bf16_dpp v18, v35, v81 row_newbcast:0 row_mask:0xf bank_mask:0xf
  v_dot2c_f32_bf16_dpp v19, v36, v81 row_newbcast:0 row_mask:0xf bank_mask:0xf
  v_dot2c_f32_bf16_dpp v20, v35, v82 row_newbcast:0 row_mask:0xf bank_mask:0xf
  v_dot2c_f32_bf16_dpp v21, v36, v82 row_newbcast:0 row_mask:0xf bank_mask:0xf
  v_dot2c_f32_bf16_dpp v22, v35, v83 row_newbcast:0 row_mask:0xf bank_mask:0xf
  v_dot2c_f32_bf16_dpp v23, v36, v83 row_newbcast:0 row_mask:0xf bank_mask:0xf
  v_dot2c_f32_bf16_dpp v16, v35, v84 row_newbcast:8 row_mask:0xf bank_mask:0xf
  v_dot2c_f32_bf16_dpp v17, v36, v84 row_newbcast:8 row_mask:0xf bank_mask:0xf
  v_dot2c_f32_bf16_dpp v18, v35, v85 row_newbcast:8 row_mask:0xf bank_mask:0xf
  v_dot2c_f32_bf16_dpp v19, v36, v85 row_newbcast:8 row_mask:0xf bank_mask:0xf
  v_dot2c_f32_bf16_dpp v20, v35, v86 row_newbcast:8 row_mask:0xf bank_mask:0xf
  v_dot2c_f32_bf16_dpp v21, v36, v86 row_newbcast:8 row_mask:0xf bank_mask:0xf
  v_dot2c_f32_bf16_dpp v22, v35, v87 row_newbcast:8 row_mask:0xf bank_mask:0xf
  v_dot2c_f32_bf16_dpp v23, v36, v87 row_newbcast:8 row_mask:0xf bank_mask:0xf
  v_dot2c_f32_bf16_dpp v16, v35, v88 row_newbcast:4 row_mask:0xf bank_mask:0xf
  v_dot2c_f32_bf16_dpp v17, v36, v88 row_newbcast:4 row_mask:0xf bank_mask:0xf
  v_dot2c_f32_bf16_dpp v18, v35, v89 row_newbcast:4 row_mask:0xf bank_mask:0xf
  v_dot2c_f32_bf16_dpp v19, v36, v89 row_newbcast:4 row_mask:0xf bank_mask:0xf
  v_dot2c_f32_bf16_dpp v20, v35, v90 row_newbcast:4 row_mask:0xf bank_mask:0xf
  v_dot2c_f32_bf16_dpp v21, v36, v90 row_newbcast:4 row_mask:0xf bank_mask:0xf
  v_dot2c_f32_bf16_dpp v22, v35, v91 row_newbcast:4 row_mask:0xf bank_mask:0xf
  v_dot2c_f32_bf16_dpp v23, v36, v91 row_newbcast:4 row_mask:0xf bank_mask:0xf
  v_dot2c_f32_bf16_dpp v16, v35, v92 row_newbcast:12 row_mask:0xf bank_mask:0xf
  v_dot2c_f32_bf16_dpp v17, v36, v92 row_newbcast:12 row_mask:0xf bank_mask:0xf
  v_dot2c_f32_bf16_dpp v18, v35, v93 row_newbcast:12 row_mask:0xf bank_mask:0xf
  v_dot2c_f32_bf16_dpp v19, v36, v93 row_newbcast:12 row_mask:0xf bank_mask:0xf
  v_dot2c_f32_bf16_dpp v20, v35, v94 row_newbcast:12 row_mask:0xf bank_mask:0xf
  v_dot2c_f32_bf16_dpp v21, v36, v94 row_newbcast:12 row_mask:0xf bank_mask:0xf
  v_dot2c_f32_bf16_dpp v22, v35, v95 row_newbcast:12 row_mask:0xf bank_mask:0xf
  v_dot2c_f32_bf16_dpp v23, v36, v95 row_newbcast:12 row_mask:0xf bank_mask:0xf
  buffer_load_dwordx4 v[80:83], v4, s[44:47], s100 offen offset:0 nt
  buffer_load_dwordx4 v[84:87], v4, s[44:47], s100 offen offset:1024 nt
  buffer_load_dwordx4 v[88:91], v4, s[44:47], s100 offen offset:2048 nt
  buffer_load_dwordx4 v[92:95], v4, s[44:47], s100 offen offset:3072 nt
  s_waitcnt vmcnt(12)
  s_add_u32 s100, s11, 8
  s_and_b32 s100, s100, 15
  s_lshl_b32 s100, s100, 15
  s_add_u32 s100, s100, s7
  v_dot2_f32_bf16 v24, v64, v12, 0
  v_dot2_f32_bf16 v25, v68, v12, 0
  v_dot2_f32_bf16 v26, v72, v12, 0
  v_dot2_f32_bf16 v27, v76, v12, 0
  v_dot2_f32_bf16 v24, v65, v13, v24
  v_dot2_f32_bf16 v25, v69, v13, v25
  v_dot2_f32_bf16 v26, v73, v13, v26
  v_dot2_f32_bf16 v27, v77, v13, v27
  v_dot2_f32_bf16 v24, v66, v14, v24
  v_dot2_f32_bf16 v25, v70, v14, v25
  v_dot2_f32_bf16 v26, v74, v14, v26
  v_dot2_f32_bf16 v27, v78, v14, v27
  v_dot2_f32_bf16 v24, v67, v15, v24
  v_dot2_f32_bf16 v25, v71, v15, v25
  v_dot2_f32_bf16 v26, v75, v15, v26
  v_dot2_f32_bf16 v27, v79, v15, v27
  buffer_load_dwordx4 v[64:67], v4, s[40:43], s100 offen offset:0 nt
  buffer_load_dwordx4 v[68:71], v4, s[40:43], s100 offen offset:1024 nt
  buffer_load_dwordx4 v[72:75], v4, s[40:43], s100 offen offset:2048 nt
  buffer_load_dwordx4 v[76:79], v4, s[40:43], s100 offen offset:3072 nt
  v_add_f32_dpp v30, v24, v24 row_ror:8 row_mask:0xf bank_mask:0x3
  s_nop 1
  v_add_f32_dpp v30, v25, v25 row_ror:8 row_mask:0xf bank_mask:0xc
  v_add_f32_dpp v31, v26, v26 row_ror:8 row_mask:0xf bank_mask:0x3
  s_nop 1
  v_add_f32_dpp v31, v27, v27 row_ror:8 row_mask:0xf bank_mask:0xc
  v_add_f32_dpp v32, v30, v30 row_shl:4 row_mask:0xf bank_mask:0x5
  s_nop 1
  v_add_f32_dpp v32, v31, v31 row_shr:4 row_mask:0xf bank_mask:0xa
  s_nop 1
  v_add_f32_dpp v32, v32, v32 quad_perm:[1,0,3,2] row_mask:0xf bank_mask:0xf
  s_nop 1
  v_add_f32_dpp v32, v32, v32 quad_perm:[2,3,0,1] row_mask:0xf bank_mask:0xf
  v_cvt_pk_bf16_f32 v32, v32, v32
  v_and_b32 v32, 0xffff0000, v32
  v_mul_f32 v32, 0x3db504f3, v32
  v_cvt_pk_bf16_f32 v32, v32, v32
  v_and_b32 v32, 0xffff0000, v32
  s_nop 1
  v_max_f32_dpp v33, v32, v32 row_ror:4 row_mask:0xf bank_mask:0xf
  s_nop 1
  v_max_f32_dpp v33, v33, v33 row_ror:8 row_mask:0xf bank_mask:0xf
  v_max_f32 v33, v33, v28
  v_cmp_gt_f32 vcc, v33, v28
  s_cbranch_vccz L_skip_11
  v_sub_f32 v37, v28, v33
  v_mul_f32 v37, 0x3fb8aa3b, v37
  v_exp_f32 v37, v37
  v_mov_b32 v28, v33
  v_mul_f32 v16, v16, v37
  v_mul_f32 v17, v17, v37
  v_mul_f32 v18, v18, v37
  v_mul_f32 v19, v19, v37
  v_mul_f32 v20, v20, v37
  v_mul_f32 v21, v21, v37
  v_mul_f32 v22, v22, v37
  v_mul_f32 v23, v23, v37
  v_mul_f32 v29, v29, v37
L_skip_11:
  v_sub_f32 v34, v32, v28
  v_mul_f32 v34, 0x3fb8aa3b, v34
  v_exp_f32 v34, v34
  s_nop 0
  v_cvt_pk_bf16_f32 v35, v34, 0
  v_cvt_pk_bf16_f32 v36, 0, v34
  v_add_f32 v29, v29, v36
  s_waitcnt vmcnt(12)
  v_dot2c_f32_bf16_dpp v16, v35, v96 row_newbcast:0 row_mask:0xf bank_mask:0xf
  v_dot2c_f32_bf16_dpp v17, v36, v96 row_newbcast:0 row_mask:0xf bank_mask:0xf
  v_dot2c_f32_bf16_dpp v18, v35, v97 row_newbcast:0 row_mask:0xf bank_mask:0xf
  v_dot2c_f32_bf16_dpp v19, v36, v97 row_newbcast:0 row_mask:0xf bank_mask:0xf
  v_dot2c_f32_bf16_dpp v20, v35, v98 row_newbcast:0 row_mask:0xf bank_mask:0xf
  v_dot2c_f32_bf16_dpp v21, v36, v98 row_newbcast:0 row_mask:0xf bank_mask:0xf
  v_dot2c_f32_bf16_dpp v22, v35, v99 row_newbcast:0 row_mask:0xf bank_mask:0xf
  v_dot2c_f32_bf16_dpp v23, v36, v99 row_newbcast:0 row_mask:0xf bank_mask:0xf
  v_dot2c_f32_bf16_dpp v16, v35, v100 row_newbcast:8 row_mask:0xf bank_mask:0xf
  v_dot2c_f32_bf16_dpp v17, v36, v100 row_newbcast:8 row_mask:0xf bank_mask:0xf
  v_dot2c_f32_bf16_dpp v18, v35, v101 row_newbcast:8 row_mask:0xf bank_mask:0xf
  v_dot2c_f32_bf16_dpp v19, v36, v101 row_newbcast:8 row_mask:0xf bank_mask:0xf
  v_dot2c_f32_bf16_dpp v20, v35, v102 row_newbcast:8 row_mask:0xf bank_mask:0xf
  v_dot2c_f32_bf16_dpp v21, v36, v102 row_newbcast:8 row_mask:0xf bank_mask:0xf
  v_dot2c_f32_bf16_dpp v22, v35, v103 row_newbcast:8 row_mask:0xf bank_mask:0xf
  v_dot2c_f32_bf16_dpp v23, v36, v103 row_newbcast:8 row_mask:0xf bank_mask:0xf
  v_dot2c_f32_bf16_dpp v16, v35, v104 row_newbcast:4 row_mask:0xf bank_mask:0xf
  v_dot2c_f32_bf16_dpp v17, v36, v104 row_newbcast:4 row_mask:0xf bank_mask:0xf
  v_dot2c_f32_bf16_dpp v18, v35, v105 row_newbcast:4 row_mask:0xf bank_mask:0xf
  v_dot2c_f32_bf16_dpp v19, v36, v105 row_newbcast:4 row_mask:0xf bank_mask:0xf
  v_dot2c_f32_bf16_dpp v20, v35, v106 row_newbcast:4 row_mask:0xf bank_mask:0xf
  v_dot2c_f32_bf16_dpp v21, v36, v106 row_newbcast:4 row_mask:0xf bank_mask:0xf
  v_dot2c_f32_bf16_dpp v22, v35, v107 row_newbcast:4 row_mask:0xf bank_mask:0xf
  v_dot2c_f32_bf16_dpp v23, v36, v107 row_newbcast:4 row_mask:0xf bank_mask:0xf
  v_dot2c_f32_bf16_dpp v16, v35, v108 row_newbcast:12 row_mask:0xf bank_mask:0xf
  v_dot2c_f32_bf16_dpp v17, v36, v108 row_newbcast:12 row_mask:0xf bank_mask:0xf
  v_dot2c_f32_bf16_dpp v18, v35, v109 row_newbcast:12 row_mask:0xf bank_mask:0xf
  v_dot2c_f32_bf16_dpp v19, v36, v109 row_newbcast:12 row_mask:0xf bank_mask:0xf
  v_dot2c_f32_bf16_dpp v20, v35, v110 row_newbcast:12 row_mask:0xf bank_mask:0xf
  v_dot2c_f32_bf16_dpp v21, v36, v110 row_newbcast:12 row_mask:0xf bank_mask:0xf
  v_dot2c_f32_bf16_dpp v22, v35, v111 row_newbcast:12 row_mask:0xf bank_mask:0xf
  v_dot2c_f32_bf16_dpp v23, v36, v111 row_newbcast:12 row_mask:0xf bank_mask:0xf
  buffer_load_dwordx4 v[96:99], v4, s[44:47], s100 offen offset:0 nt
  buffer_load_dwordx4 v[100:103], v4, s[44:47], s100 offen offset:1024 nt
  buffer_load_dwordx4 v[104:107], v4, s[44:47], s100 offen offset:2048 nt
  buffer_load_dwordx4 v[108:111], v4, s[44:47], s100 offen offset:3072 nt
  s_waitcnt vmcnt(12)
  s_add_u32 s100, s11, 9
  s_and_b32 s100, s100, 15
  s_lshl_b32 s100, s100, 15
  s_add_u32 s100, s100, s7
  v_dot2_f32_bf16 v24, v48, v12, 0
  v_dot2_f32_bf16 v25, v52, v12, 0
  v_dot2_f32_bf16 v26, v56, v12, 0
  v_dot2_f32_bf16 v27, v60, v12, 0
  v_dot2_f32_bf16 v24, v49, v13, v24
  v_dot2_f32_bf16 v25, v53, v13, v25
  v_dot2_f32_bf16 v26, v57, v13, v26
  v_dot2_f32_bf16 v27, v61, v13, v27
  v_dot2_f32_bf16 v24, v50, v14, v24
  v_dot2_f32_bf16 v25, v54, v14, v25
  v_dot2_f32_bf16 v26, v58, v14, v26
  v_dot2_f32_bf16 v27, v62, v14, v27
  v_dot2_f32_bf16 v24, v51, v15, v24
  v_dot2_f32_bf16 v25, v55, v15, v25
  v_dot2_f32_bf16 v26, v59, v15, v26
  v_dot2_f32_bf16 v27, v63, v15, v27
  buffer_load_dwordx4 v[48:51], v4, s[40:43], s100 offen offset:0 nt
  buffer_load_dwordx4 v[52:55], v4, s[40:43], s100 offen offset:1024 nt
  buffer_load_dwordx4 v[56:59], v4, s[40:43], s100 offen offset:2048 nt
  buffer_load_dwordx4 v[60:63], v4, s[40:43], s100 offen offset:3072 nt
  v_add_f32_dpp v30, v24, v24 row_ror:8 row_mask:0xf bank_mask:0x3
  s_nop 1
  v_add_f32_dpp v30, v25, v25 row_ror:8 row_mask:0xf bank_mask:0xc
  v_add_f32_dpp v31, v26, v26 row_ror:8 row_mask:0xf bank_mask:0x3
  s_nop 1
  v_add_f32_dpp v31, v27, v27 row_ror:8 row_mask:0xf bank_mask:0xc
  v_add_f32_dpp v32, v30, v30 row_shl:4 row_mask:0xf bank_mask:0x5
  s_nop 1
  v_add_f32_dpp v32, v31, v31 row_shr:4 row_mask:0xf bank_mask:0xa
  s_nop 1
  v_add_f32_dpp v32, v32, v32 quad_perm:[1,0,3,2] row_mask:0xf bank_mask:0xf
  s_nop 1
  v_add_f32_dpp v32, v32, v32 quad_perm:[2,3,0,1] row_mask:0xf bank_mask:0xf
  v_cvt_pk_bf16_f32 v32, v32, v32
  v_and_b32 v32, 0xffff0000, v32
  v_mul_f32 v32, 0x3db504f3, v32
  v_cvt_pk_bf16_f32 v32, v32, v32
  v_and_b32 v32, 0xffff0000, v32
  s_nop 1
  v_max_f32_dpp v33, v32, v32 row_ror:4 row_mask:0xf bank_mask:0xf
  s_nop 1
  v_max_f32_dpp v33, v33, v33 row_ror:8 row_mask:0xf bank_mask:0xf
  v_max_f32 v33, v33, v28
  v_cmp_gt_f32 vcc, v33, v28
  s_cbranch_vccz L_skip_12
  v_sub_f32 v37, v28, v33
  v_mul_f32 v37, 0x3fb8aa3b, v37
  v_exp_f32 v37, v37
  v_mov_b32 v28, v33
  v_mul_f32 v16, v16, v37
  v_mul_f32 v17, v17, v37
  v_mul_f32 v18, v18, v37
  v_mul_f32 v19, v19, v37
  v_mul_f32 v20, v20, v37
  v_mul_f32 v21, v21, v37
  v_mul_f32 v22, v22, v37
  v_mul_f32 v23, v23, v37
  v_mul_f32 v29, v29, v37
L_skip_12:
  v_sub_f32 v34, v32, v28
  v_mul_f32 v34, 0x3fb8aa3b, v34
  v_exp_f32 v34, v34
  s_nop 0
  v_cvt_pk_bf16_f32 v35, v34, 0
  v_cvt_pk_bf16_f32 v36, 0, v34
  v_add_f32 v29, v29, v36
  s_waitcnt vmcnt(12)
  v_dot2c_f32_bf16_dpp v16, v35, v80 row_newbcast:0 row_mask:0xf bank_mask:0xf
  v_dot2c_f32_bf16_dpp v17, v36, v80 row_newbcast:0 row_mask:0xf bank_mask:0xf
  v_dot2c_f32_bf16_dpp v18, v35, v81 row_newbcast:0 row_mask:0xf bank_mask:0xf
  v_dot2c_f32_bf16_dpp v19, v36, v81 row_newbcast:0 row_mask:0xf bank_mask:0xf
  v_dot2c_f32_bf16_dpp v20, v35, v82 row_newbcast:0 row_mask:0xf bank_mask:0xf
  v_dot2c_f32_bf16_dpp v21, v36, v82 row_newbcast:0 row_mask:0xf bank_mask:0xf
  v_dot2c_f32_bf16_dpp v22, v35, v83 row_newbcast:0 row_mask:0xf bank_mask:0xf
  v_dot2c_f32_bf16_dpp v23, v36, v83 row_newbcast:0 row_mask:0xf bank_mask:0xf
  v_dot2c_f32_bf16_dpp v16, v35, v84 row_newbcast:8 row_mask:0xf bank_mask:0xf
  v_dot2c_f32_bf16_dpp v17, v36, v84 row_newbcast:8 row_mask:0xf bank_mask:0xf
  v_dot2c_f32_bf16_dpp v18, v35, v85 row_newbcast:8 row_mask:0xf bank_mask:0xf
  v_dot2c_f32_bf16_dpp v19, v36, v85 row_newbcast:8 row_mask:0xf bank_mask:0xf
  v_dot2c_f32_bf16_dpp v20, v35, v86 row_newbcast:8 row_mask:0xf bank_mask:0xf
  v_dot2c_f32_bf16_dpp v21, v36, v86 row_newbcast:8 row_mask:0xf bank_mask:0xf
  v_dot2c_f32_bf16_dpp v22, v35, v87 row_newbcast:8 row_mask:0xf bank_mask:0xf
  v_dot2c_f32_bf16_dpp v23, v36, v87 row_newbcast:8 row_mask:0xf bank_mask:0xf
  v_dot2c_f32_bf16_dpp v16, v35, v88 row_newbcast:4 row_mask:0xf bank_mask:0xf
  v_dot2c_f32_bf16_dpp v17, v36, v88 row_newbcast:4 row_mask:0xf bank_mask:0xf
  v_dot2c_f32_bf16_dpp v18, v35, v89 row_newbcast:4 row_mask:0xf bank_mask:0xf
  v_dot2c_f32_bf16_dpp v19, v36, v89 row_newbcast:4 row_mask:0xf bank_mask:0xf
  v_dot2c_f32_bf16_dpp v20, v35, v90 row_newbcast:4 row_mask:0xf bank_mask:0xf
  v_dot2c_f32_bf16_dpp v21, v36, v90 row_newbcast:4 row_mask:0xf bank_mask:0xf
  v_dot2c_f32_bf16_dpp v22, v35, v91 row_newbcast:4 row_mask:0xf bank_mask:0xf
  v_dot2c_f32_bf16_dpp v23, v36, v91 row_newbcast:4 row_mask:0xf bank_mask:0xf
  v_dot2c_f32_bf16_dpp v16, v35, v92 row_newbcast:12 row_mask:0xf bank_mask:0xf
  v_dot2c_f32_bf16_dpp v17, v36, v92 row_newbcast:12 row_mask:0xf bank_mask:0xf
  v_dot2c_f32_bf16_dpp v18, v35, v93 row_newbcast:12 row_mask:0xf bank_mask:0xf
  v_dot2c_f32_bf16_dpp v19, v36, v93 row_newbcast:12 row_mask:0xf bank_mask:0xf
  v_dot2c_f32_bf16_dpp v20, v35, v94 row_newbcast:12 row_mask:0xf bank_mask:0xf
  v_dot2c_f32_bf16_dpp v21, v36, v94 row_newbcast:12 row_mask:0xf bank_mask:0xf
  v_dot2c_f32_bf16_dpp v22, v35, v95 row_newbcast:12 row_mask:0xf bank_mask:0xf
  v_dot2c_f32_bf16_dpp v23, v36, v95 row_newbcast:12 row_mask:0xf bank_mask:0xf
  buffer_load_dwordx4 v[80:83], v4, s[44:47], s100 offen offset:0 nt
  buffer_load_dwordx4 v[84:87], v4, s[44:47], s100 offen offset:1024 nt
  buffer_load_dwordx4 v[88:91], v4, s[44:47], s100 offen offset:2048 nt
  buffer_load_dwordx4 v[92:95], v4, s[44:47], s100 offen offset:3072 nt
  s_waitcnt vmcnt(12)
  s_mul_i32 s8, s4, 163840
  buffer_load_dwordx4 v[112:115], v45, s[52:55], s8 offen offset:0
  buffer_load_dwordx4 v[116:119], v45, s[52:55], s8 offen offset:256
  buffer_load_dwordx4 v[120:123], v45, s[52:55], s8 offen offset:512
  buffer_load_dwordx4 v[124:127], v45, s[52:55], s8 offen offset:768
  buffer_load_dwordx4 v[128:131], v45, s[52:55], s8 offen offset:1024
  s_add_u32 s100, s11, 10
  s_and_b32 s100, s100, 15
  s_lshl_b32 s100, s100, 15
  s_add_u32 s100, s100, s7
  v_dot2_f32_bf16 v24, v64, v12, 0
  v_dot2_f32_bf16 v25, v68, v12, 0
  v_dot2_f32_bf16 v26, v72, v12, 0
  v_dot2_f32_bf16 v27, v76, v12, 0
  v_dot2_f32_bf16 v24, v65, v13, v24
  v_dot2_f32_bf16 v25, v69, v13, v25
  v_dot2_f32_bf16 v26, v73, v13, v26
  v_dot2_f32_bf16 v27, v77, v13, v27
  v_dot2_f32_bf16 v24, v66, v14, v24
  v_dot2_f32_bf16 v25, v70, v14, v25
  v_dot2_f32_bf16 v26, v74, v14, v26
  v_dot2_f32_bf16 v27, v78, v14, v27
  v_dot2_f32_bf16 v24, v67, v15, v24
  v_dot2_f32_bf16 v25, v71, v15, v25
  v_dot2_f32_bf16 v26, v75, v15, v26
  v_dot2_f32_bf16 v27, v79, v15, v27
  buffer_load_dwordx4 v[64:67], v4, s[40:43], s100 offen offset:0 nt
  buffer_load_dwordx4 v[68:71], v4, s[40:43], s100 offen offset:1024 nt
  buffer_load_dwordx4 v[72:75], v4, s[40:43], s100 offen offset:2048 nt
  buffer_load_dwordx4 v[76:79], v4, s[40:43], s100 offen offset:3072 nt
  v_add_f32_dpp v30, v24, v24 row_ror:8 row_mask:0xf bank_mask:0x3
  s_nop 1
  v_add_f32_dpp v30, v25, v25 row_ror:8 row_mask:0xf bank_mask:0xc
  v_add_f32_dpp v31, v26, v26 row_ror:8 row_mask:0xf bank_mask:0x3
  s_nop 1
  v_add_f32_dpp v31, v27, v27 row_ror:8 row_mask:0xf bank_mask:0xc
  v_add_f32_dpp v32, v30, v30 row_shl:4 row_mask:0xf bank_mask:0x5
  s_nop 1
  v_add_f32_dpp v32, v31, v31 row_shr:4 row_mask:0xf bank_mask:0xa
  s_nop 1
  v_add_f32_dpp v32, v32, v32 quad_perm:[1,0,3,2] row_mask:0xf bank_mask:0xf
  s_nop 1
  v_add_f32_dpp v32, v32, v32 quad_perm:[2,3,0,1] row_mask:0xf bank_mask:0xf
  v_cvt_pk_bf16_f32 v32, v32, v32
  v_and_b32 v32, 0xffff0000, v32
  v_mul_f32 v32, 0x3db504f3, v32
  v_cvt_pk_bf16_f32 v32, v32, v32
  v_and_b32 v32, 0xffff0000, v32
  s_nop 1
  v_max_f32_dpp v33, v32, v32 row_ror:4 row_mask:0xf bank_mask:0xf
  s_nop 1
  v_max_f32_dpp v33, v33, v33 row_ror:8 row_mask:0xf bank_mask:0xf
  v_max_f32 v33, v33, v28
  v_cmp_gt_f32 vcc, v33, v28
  s_cbranch_vccz L_skip_13
  v_sub_f32 v37, v28, v33
  v_mul_f32 v37, 0x3fb8aa3b, v37
  v_exp_f32 v37, v37
  v_mov_b32 v28, v33
  v_mul_f32 v16, v16, v37
  v_mul_f32 v17, v17, v37
  v_mul_f32 v18, v18, v37
  v_mul_f32 v19, v19, v37
  v_mul_f32 v20, v20, v37
  v_mul_f32 v21, v21, v37
  v_mul_f32 v22, v22, v37
  v_mul_f32 v23, v23, v37
  v_mul_f32 v29, v29, v37
L_skip_13:
  v_sub_f32 v34, v32, v28
  v_mul_f32 v34, 0x3fb8aa3b, v34
  v_exp_f32 v34, v34
  s_nop 0
  v_cvt_pk_bf16_f32 v35, v34, 0
  v_cvt_pk_bf16_f32 v36, 0, v34
  v_add_f32 v29, v29, v36
  s_waitcnt vmcnt(17)
  v_dot2c_f32_bf16_dpp v16, v35, v96 row_newbcast:0 row_mask:0xf bank_mask:0xf
  v_dot2c_f32_bf16_dpp v17, v36, v96 row_newbcast:0 row_mask:0xf bank_mask:0xf
  v_dot2c_f32_bf16_dpp v18, v35, v97 row_newbcast:0 row_mask:0xf bank_mask:0xf
  v_dot2c_f32_bf16_dpp v19, v36, v97 row_newbcast:0 row_mask:0xf bank_mask:0xf
  v_dot2c_f32_bf16_dpp v20, v35, v98 row_newbcast:0 row_mask:0xf bank_mask:0xf
  v_dot2c_f32_bf16_dpp v21, v36, v98 row_newbcast:0 row_mask:0xf bank_mask:0xf
  v_dot2c_f32_bf16_dpp v22, v35, v99 row_newbcast:0 row_mask:0xf bank_mask:0xf
  v_dot2c_f32_bf16_dpp v23, v36, v99 row_newbcast:0 row_mask:0xf bank_mask:0xf
  v_dot2c_f32_bf16_dpp v16, v35, v100 row_newbcast:8 row_mask:0xf bank_mask:0xf
  v_dot2c_f32_bf16_dpp v17, v36, v100 row_newbcast:8 row_mask:0xf bank_mask:0xf
  v_dot2c_f32_bf16_dpp v18, v35, v101 row_newbcast:8 row_mask:0xf bank_mask:0xf
  v_dot2c_f32_bf16_dpp v19, v36, v101 row_newbcast:8 row_mask:0xf bank_mask:0xf
  v_dot2c_f32_bf16_dpp v20, v35, v102 row_newbcast:8 row_mask:0xf bank_mask:0xf
  v_dot2c_f32_bf16_dpp v21, v36, v102 row_newbcast:8 row_mask:0xf bank_mask:0xf
  v_dot2c_f32_bf16_dpp v22, v35, v103 row_newbcast:8 row_mask:0xf bank_mask:0xf
  v_dot2c_f32_bf16_dpp v23, v36, v103 row_newbcast:8 row_mask:0xf bank_mask:0xf
  v_dot2c_f32_bf16_dpp v16, v35, v104 row_newbcast:4 row_mask:0xf bank_mask:0xf
  v_dot2c_f32_bf16_dpp v17, v36, v104 row_newbcast:4 row_mask:0xf bank_mask:0xf
  v_dot2c_f32_bf16_dpp v18, v35, v105 row_newbcast:4 row_mask:0xf bank_mask:0xf
  v_dot2c_f32_bf16_dpp v19, v36, v105 row_newbcast:4 row_mask:0xf bank_mask:0xf
  v_dot2c_f32_bf16_dpp v20, v35, v106 row_newbcast:4 row_mask:0xf bank_mask:0xf
  v_dot2c_f32_bf16_dpp v21, v36, v106 row_newbcast:4 row_mask:0xf bank_mask:0xf
  v_dot2c_f32_bf16_dpp v22, v35, v107 row_newbcast:4 row_mask:0xf bank_mask:0xf
  v_dot2c_f32_bf16_dpp v23, v36, v107 row_newbcast:4 row_mask:0xf bank_mask:0xf
  v_dot2c_f32_bf16_dpp v16, v35, v108 row_newbcast:12 row_mask:0xf bank_mask:0xf
  v_dot2c_f32_bf16_dpp v17, v36, v108 row_newbcast:12 row_mask:0xf bank_mask:0xf
  v_dot2c_f32_bf16_dpp v18, v35, v109 row_newbcast:12 row_mask:0xf bank_mask:0xf
  v_dot2c_f32_bf16_dpp v19, v36, v109 row_newbcast:12 row_mask:0xf bank_mask:0xf
  v_dot2c_f32_bf16_dpp v20, v35, v110 row_newbcast:12 row_mask:0xf bank_mask:0xf
  v_dot2c_f32_bf16_dpp v21, v36, v110 row_newbcast:12 row_mask:0xf bank_mask:0xf
  v_dot2c_f32_bf16_dpp v22, v35, v111 row_newbcast:12 row_mask:0xf bank_mask:0xf
  v_dot2c_f32_bf16_dpp v23, v36, v111 row_newbcast:12 row_mask:0xf bank_mask:0xf
  buffer_load_dwordx4 v[96:99], v4, s[44:47], s100 offen offset:0 nt
  buffer_load_dwordx4 v[100:103], v4, s[44:47], s100 offen offset:1024 nt
  buffer_load_dwordx4 v[104:107], v4, s[44:47], s100 offen offset:2048 nt
  buffer_load_dwordx4 v[108:111], v4, s[44:47], s100 offen offset:3072 nt
  s_waitcnt vmcnt(17)
  s_mul_i32 s8, s4, 163840
  buffer_load_dwordx4 v[132:135], v45, s[52:55], s8 offen offset:1280
  buffer_load_dwordx4 v[136:139], v45, s[52:55], s8 offen offset:1536
  buffer_load_dwordx4 v[140:143], v45, s[52:55], s8 offen offset:1792
  buffer_load_dwordx4 v[144:147], v45, s[52:55], s8 offen offset:2048
  buffer_load_dwordx4 v[148:151], v45, s[52:55], s8 offen offset:2304
  s_add_u32 s100, s11, 11
  s_and_b32 s100, s100, 15
  s_lshl_b32 s100, s100, 15
  s_add_u32 s100, s100, s7
  v_dot2_f32_bf16 v24, v48, v12, 0
  v_dot2_f32_bf16 v25, v52, v12, 0
  v_dot2_f32_bf16 v26, v56, v12, 0
  v_dot2_f32_bf16 v27, v60, v12, 0
  v_dot2_f32_bf16 v24, v49, v13, v24
  v_dot2_f32_bf16 v25, v53, v13, v25
  v_dot2_f32_bf16 v26, v57, v13, v26
  v_dot2_f32_bf16 v27, v61, v13, v27
  v_dot2_f32_bf16 v24, v50, v14, v24
  v_dot2_f32_bf16 v25, v54, v14, v25
  v_dot2_f32_bf16 v26, v58, v14, v26
  v_dot2_f32_bf16 v27, v62, v14, v27
  v_dot2_f32_bf16 v24, v51, v15, v24
  v_dot2_f32_bf16 v25, v55, v15, v25
  v_dot2_f32_bf16 v26, v59, v15, v26
  v_dot2_f32_bf16 v27, v63, v15, v27
  buffer_load_dwordx4 v[48:51], v4, s[40:43], s100 offen offset:0 nt
  buffer_load_dwordx4 v[52:55], v4, s[40:43], s100 offen offset:1024 nt
  buffer_load_dwordx4 v[56:59], v4, s[40:43], s100 offen offset:2048 nt
  buffer_load_dwordx4 v[60:63], v4, s[40:43], s100 offen offset:3072 nt
  v_add_f32_dpp v30, v24, v24 row_ror:8 row_mask:0xf bank_mask:0x3
  s_nop 1
  v_add_f32_dpp v30, v25, v25 row_ror:8 row_mask:0xf bank_mask:0xc
  v_add_f32_dpp v31, v26, v26 row_ror:8 row_mask:0xf bank_mask:0x3
  s_nop 1
  v_add_f32_dpp v31, v27, v27 row_ror:8 row_mask:0xf bank_mask:0xc
  v_add_f32_dpp v32, v30, v30 row_shl:4 row_mask:0xf bank_mask:0x5
  s_nop 1
  v_add_f32_dpp v32, v31, v31 row_shr:4 row_mask:0xf bank_mask:0xa
  s_nop 1
  v_add_f32_dpp v32, v32, v32 quad_perm:[1,0,3,2] row_mask:0xf bank_mask:0xf
  s_nop 1
  v_add_f32_dpp v32, v32, v32 quad_perm:[2,3,0,1] row_mask:0xf bank_mask:0xf
  v_cvt_pk_bf16_f32 v32, v32, v32
  v_and_b32 v32, 0xffff0000, v32
  v_mul_f32 v32, 0x3db504f3, v32
  v_cvt_pk_bf16_f32 v32, v32, v32
  v_and_b32 v32, 0xffff0000, v32
  s_nop 1
  v_max_f32_dpp v33, v32, v32 row_ror:4 row_mask:0xf bank_mask:0xf
  s_nop 1
  v_max_f32_dpp v33, v33, v33 row_ror:8 row_mask:0xf bank_mask:0xf
  v_max_f32 v33, v33, v28
  v_cmp_gt_f32 vcc, v33, v28
  s_cbranch_vccz L_skip_14
  v_sub_f32 v37, v28, v33
  v_mul_f32 v37, 0x3fb8aa3b, v37
  v_exp_f32 v37, v37
  v_mov_b32 v28, v33
  v_mul_f32 v16, v16, v37
  v_mul_f32 v17, v17, v37
  v_mul_f32 v18, v18, v37
  v_mul_f32 v19, v19, v37
  v_mul_f32 v20, v20, v37
  v_mul_f32 v21, v21, v37
  v_mul_f32 v22, v22, v37
  v_mul_f32 v23, v23, v37
  v_mul_f32 v29, v29, v37
L_skip_14:
  v_sub_f32 v34, v32, v28
  v_mul_f32 v34, 0x3fb8aa3b, v34
  v_exp_f32 v34, v34
  s_nop 0
  v_cvt_pk_bf16_f32 v35, v34, 0
  v_cvt_pk_bf16_f32 v36, 0, v34
  v_add_f32 v29, v29, v36
  s_waitcnt vmcnt(22)
  v_dot2c_f32_bf16_dpp v16, v35, v80 row_newbcast:0 row_mask:0xf bank_mask:0xf
  v_dot2c_f32_bf16_dpp v17, v36, v80 row_newbcast:0 row_mask:0xf bank_mask:0xf
  v_dot2c_f32_bf16_dpp v18, v35, v81 row_newbcast:0 row_mask:0xf bank_mask:0xf
  v_dot2c_f32_bf16_dpp v19, v36, v81 row_newbcast:0 row_mask:0xf bank_mask:0xf
  v_dot2c_f32_bf16_dpp v20, v35, v82 row_newbcast:0 row_mask:0xf bank_mask:0xf
  v_dot2c_f32_bf16_dpp v21, v36, v82 row_newbcast:0 row_mask:0xf bank_mask:0xf
  v_dot2c_f32_bf16_dpp v22, v35, v83 row_newbcast:0 row_mask:0xf bank_mask:0xf
  v_dot2c_f32_bf16_dpp v23, v36, v83 row_newbcast:0 row_mask:0xf bank_mask:0xf
  v_dot2c_f32_bf16_dpp v16, v35, v84 row_newbcast:8 row_mask:0xf bank_mask:0xf
  v_dot2c_f32_bf16_dpp v17, v36, v84 row_newbcast:8 row_mask:0xf bank_mask:0xf
  v_dot2c_f32_bf16_dpp v18, v35, v85 row_newbcast:8 row_mask:0xf bank_mask:0xf
  v_dot2c_f32_bf16_dpp v19, v36, v85 row_newbcast:8 row_mask:0xf bank_mask:0xf
  v_dot2c_f32_bf16_dpp v20, v35, v86 row_newbcast:8 row_mask:0xf bank_mask:0xf
  v_dot2c_f32_bf16_dpp v21, v36, v86 row_newbcast:8 row_mask:0xf bank_mask:0xf
  v_dot2c_f32_bf16_dpp v22, v35, v87 row_newbcast:8 row_mask:0xf bank_mask:0xf
  v_dot2c_f32_bf16_dpp v23, v36, v87 row_newbcast:8 row_mask:0xf bank_mask:0xf
  v_dot2c_f32_bf16_dpp v16, v35, v88 row_newbcast:4 row_mask:0xf bank_mask:0xf
  v_dot2c_f32_bf16_dpp v17, v36, v88 row_newbcast:4 row_mask:0xf bank_mask:0xf
  v_dot2c_f32_bf16_dpp v18, v35, v89 row_newbcast:4 row_mask:0xf bank_mask:0xf
  v_dot2c_f32_bf16_dpp v19, v36, v89 row_newbcast:4 row_mask:0xf bank_mask:0xf
  v_dot2c_f32_bf16_dpp v20, v35, v90 row_newbcast:4 row_mask:0xf bank_mask:0xf
  v_dot2c_f32_bf16_dpp v21, v36, v90 row_newbcast:4 row_mask:0xf bank_mask:0xf
  v_dot2c_f32_bf16_dpp v22, v35, v91 row_newbcast:4 row_mask:0xf bank_mask:0xf
  v_dot2c_f32_bf16_dpp v23, v36, v91 row_newbcast:4 row_mask:0xf bank_mask:0xf
  v_dot2c_f32_bf16_dpp v16, v35, v92 row_newbcast:12 row_mask:0xf bank_mask:0xf
  v_dot2c_f32_bf16_dpp v17, v36, v92 row_newbcast:12 row_mask:0xf bank_mask:0xf
  v_dot2c_f32_bf16_dpp v18, v35, v93 row_newbcast:12 row_mask:0xf bank_mask:0xf
  v_dot2c_f32_bf16_dpp v19, v36, v93 row_newbcast:12 row_mask:0xf bank_mask:0xf
  v_dot2c_f32_bf16_dpp v20, v35, v94 row_newbcast:12 row_mask:0xf bank_mask:0xf
  v_dot2c_f32_bf16_dpp v21, v36, v94 row_newbcast:12 row_mask:0xf bank_mask:0xf
  v_dot2c_f32_bf16_dpp v22, v35, v95 row_newbcast:12 row_mask:0xf bank_mask:0xf
  v_dot2c_f32_bf16_dpp v23, v36, v95 row_newbcast:12 row_mask:0xf bank_mask:0xf
  buffer_load_dwordx4 v[80:83], v4, s[44:47], s100 offen offset:0 nt
  buffer_load_dwordx4 v[84:87], v4, s[44:47], s100 offen offset:1024 nt
  buffer_load_dwordx4 v[88:91], v4, s[44:47], s100 offen offset:2048 nt
  buffer_load_dwordx4 v[92:95], v4, s[44:47], s100 offen offset:3072 nt
  s_waitcnt vmcnt(17)
  s_mul_i32 s8, s4, 163840
  s_add_u32 s8, s8, 2560
  buffer_load_dwordx4 v[152:155], v45, s[52:55], s8 offen offset:0
  buffer_load_dwordx4 v[156:159], v45, s[52:55], s8 offen offset:256
  buffer_load_dwordx4 v[160:163], v45, s[52:55], s8 offen offset:512
  buffer_load_dwordx4 v[164:167], v45, s[52:55], s8 offen offset:768
  buffer_load_dwordx4 v[168:171], v45, s[52:55], s8 offen offset:1024
  s_add_u32 s100, s11, 12
  s_and_b32 s100, s100, 15
  s_lshl_b32 s100, s100, 15
  s_add_u32 s100, s100, s7
  v_dot2_f32_bf16 v24, v64, v12, 0
  v_dot2_f32_bf16 v25, v68, v12, 0
  v_dot2_f32_bf16 v26, v72, v12, 0
  v_dot2_f32_bf16 v27, v76, v12, 0
  v_dot2_f32_bf16 v24, v65, v13, v24
  v_dot2_f32_bf16 v25, v69, v13, v25
  v_dot2_f32_bf16 v26, v73, v13, v26
  v_dot2_f32_bf16 v27, v77, v13, v27
  v_dot2_f32_bf16 v24, v66, v14, v24
  v_dot2_f32_bf16 v25, v70, v14, v25
  v_dot2_f32_bf16 v26, v74, v14, v26
  v_dot2_f32_bf16 v27, v78, v14, v27
  v_dot2_f32_bf16 v24, v67, v15, v24
  v_dot2_f32_bf16 v25, v71, v15, v25
  v_dot2_f32_bf16 v26, v75, v15, v26
  v_dot2_f32_bf16 v27, v79, v15, v27
  buffer_load_dwordx4 v[64:67], v4, s[40:43], s100 offen offset:0 nt
  buffer_load_dwordx4 v[68:71], v4, s[40:43], s100 offen offset:1024 nt
  buffer_load_dwordx4 v[72:75], v4, s[40:43], s100 offen offset:2048 nt
  buffer_load_dwordx4 v[76:79], v4, s[40:43], s100 offen offset:3072 nt
  v_add_f32_dpp v30, v24, v24 row_ror:8 row_mask:0xf bank_mask:0x3
  s_nop 1
  v_add_f32_dpp v30, v25, v25 row_ror:8 row_mask:0xf bank_mask:0xc
  v_add_f32_dpp v31, v26, v26 row_ror:8 row_mask:0xf bank_mask:0x3
  s_nop 1
  v_add_f32_dpp v31, v27, v27 row_ror:8 row_mask:0xf bank_mask:0xc
  v_add_f32_dpp v32, v30, v30 row_shl:4 row_mask:0xf bank_mask:0x5
  s_nop 1
  v_add_f32_dpp v32, v31, v31 row_shr:4 row_mask:0xf bank_mask:0xa
  s_nop 1
  v_add_f32_dpp v32, v32, v32 quad_perm:[1,0,3,2] row_mask:0xf bank_mask:0xf
  s_nop 1
  v_add_f32_dpp v32, v32, v32 quad_perm:[2,3,0,1] row_mask:0xf bank_mask:0xf
  v_cvt_pk_bf16_f32 v32, v32, v32
  v_and_b32 v32, 0xffff0000, v32
  v_mul_f32 v32, 0x3db504f3, v32
  v_cvt_pk_bf16_f32 v32, v32, v32
  v_and_b32 v32, 0xffff0000, v32
  s_nop 1
  v_max_f32_dpp v33, v32, v32 row_ror:4 row_mask:0xf bank_mask:0xf
  s_nop 1
  v_max_f32_dpp v33, v33, v33 row_ror:8 row_mask:0xf bank_mask:0xf
  v_max_f32 v33, v33, v28
  v_cmp_gt_f32 vcc, v33, v28
  s_cbranch_vccz L_skip_15
  v_sub_f32 v37, v28, v33
  v_mul_f32 v37, 0x3fb8aa3b, v37
  v_exp_f32 v37, v37
  v_mov_b32 v28, v33
  v_mul_f32 v16, v16, v37
  v_mul_f32 v17, v17, v37
  v_mul_f32 v18, v18, v37
  v_mul_f32 v19, v19, v37
  v_mul_f32 v20, v20, v37
  v_mul_f32 v21, v21, v37
  v_mul_f32 v22, v22, v37
  v_mul_f32 v23, v23, v37
  v_mul_f32 v29, v29, v37
L_skip_15:
  v_sub_f32 v34, v32, v28
  v_mul_f32 v34, 0x3fb8aa3b, v34
  v_exp_f32 v34, v34
  s_nop 0
  v_cvt_pk_bf16_f32 v35, v34, 0
  v_cvt_pk_bf16_f32 v36, 0, v34
  v_add_f32 v29, v29, v36
  s_waitcnt vmcnt(22)
  v_dot2c_f32_bf16_dpp v16, v35, v96 row_newbcast:0 row_mask:0xf bank_mask:0xf
  v_dot2c_f32_bf16_dpp v17, v36, v96 row_newbcast:0 row_mask:0xf bank_mask:0xf
  v_dot2c_f32_bf16_dpp v18, v35, v97 row_newbcast:0 row_mask:0xf bank_mask:0xf
  v_dot2c_f32_bf16_dpp v19, v36, v97 row_newbcast:0 row_mask:0xf bank_mask:0xf
  v_dot2c_f32_bf16_dpp v20, v35, v98 row_newbcast:0 row_mask:0xf bank_mask:0xf
  v_dot2c_f32_bf16_dpp v21, v36, v98 row_newbcast:0 row_mask:0xf bank_mask:0xf
  v_dot2c_f32_bf16_dpp v22, v35, v99 row_newbcast:0 row_mask:0xf bank_mask:0xf
  v_dot2c_f32_bf16_dpp v23, v36, v99 row_newbcast:0 row_mask:0xf bank_mask:0xf
  v_dot2c_f32_bf16_dpp v16, v35, v100 row_newbcast:8 row_mask:0xf bank_mask:0xf
  v_dot2c_f32_bf16_dpp v17, v36, v100 row_newbcast:8 row_mask:0xf bank_mask:0xf
  v_dot2c_f32_bf16_dpp v18, v35, v101 row_newbcast:8 row_mask:0xf bank_mask:0xf
  v_dot2c_f32_bf16_dpp v19, v36, v101 row_newbcast:8 row_mask:0xf bank_mask:0xf
  v_dot2c_f32_bf16_dpp v20, v35, v102 row_newbcast:8 row_mask:0xf bank_mask:0xf
  v_dot2c_f32_bf16_dpp v21, v36, v102 row_newbcast:8 row_mask:0xf bank_mask:0xf
  v_dot2c_f32_bf16_dpp v22, v35, v103 row_newbcast:8 row_mask:0xf bank_mask:0xf
  v_dot2c_f32_bf16_dpp v23, v36, v103 row_newbcast:8 row_mask:0xf bank_mask:0xf
  v_dot2c_f32_bf16_dpp v16, v35, v104 row_newbcast:4 row_mask:0xf bank_mask:0xf
  v_dot2c_f32_bf16_dpp v17, v36, v104 row_newbcast:4 row_mask:0xf bank_mask:0xf
  v_dot2c_f32_bf16_dpp v18, v35, v105 row_newbcast:4 row_mask:0xf bank_mask:0xf
  v_dot2c_f32_bf16_dpp v19, v36, v105 row_newbcast:4 row_mask:0xf bank_mask:0xf
  v_dot2c_f32_bf16_dpp v20, v35, v106 row_newbcast:4 row_mask:0xf bank_mask:0xf
  v_dot2c_f32_bf16_dpp v21, v36, v106 row_newbcast:4 row_mask:0xf bank_mask:0xf
  v_dot2c_f32_bf16_dpp v22, v35, v107 row_newbcast:4 row_mask:0xf bank_mask:0xf
  v_dot2c_f32_bf16_dpp v23, v36, v107 row_newbcast:4 row_mask:0xf bank_mask:0xf
  v_dot2c_f32_bf16_dpp v16, v35, v108 row_newbcast:12 row_mask:0xf bank_mask:0xf
  v_dot2c_f32_bf16_dpp v17, v36, v108 row_newbcast:12 row_mask:0xf bank_mask:0xf
  v_dot2c_f32_bf16_dpp v18, v35, v109 row_newbcast:12 row_mask:0xf bank_mask:0xf
  v_dot2c_f32_bf16_dpp v19, v36, v109 row_newbcast:12 row_mask:0xf bank_mask:0xf
  v_dot2c_f32_bf16_dpp v20, v35, v110 row_newbcast:12 row_mask:0xf bank_mask:0xf
  v_dot2c_f32_bf16_dpp v21, v36, v110 row_newbcast:12 row_mask:0xf bank_mask:0xf
  v_dot2c_f32_bf16_dpp v22, v35, v111 row_newbcast:12 row_mask:0xf bank_mask:0xf
  v_dot2c_f32_bf16_dpp v23, v36, v111 row_newbcast:12 row_mask:0xf bank_mask:0xf
  buffer_load_dwordx4 v[96:99], v4, s[44:47], s100 offen offset:0 nt
  buffer_load_dwordx4 v[100:103], v4, s[44:47], s100 offen offset:1024 nt
  buffer_load_dwordx4 v[104:107], v4, s[44:47], s100 offen offset:2048 nt
  buffer_load_dwordx4 v[108:111], v4, s[44:47], s100 offen offset:3072 nt
  s_waitcnt vmcnt(17)
  s_mul_i32 s8, s4, 163840
  s_add_u32 s8, s8, 2560
  buffer_load_dwordx4 v[172:175], v45, s[52:55], s8 offen offset:1280
  buffer_load_dwordx4 v[176:179], v45, s[52:55], s8 offen offset:1536
  buffer_load_dwordx4 v[180:183], v45, s[52:55], s8 offen offset:1792
  buffer_load_dwordx4 v[184:187], v45, s[52:55], s8 offen offset:2048
  buffer_load_dwordx4 v[188:191], v45, s[52:55], s8 offen offset:2304
  s_add_u32 s100, s11, 13
  s_and_b32 s100, s100, 15
  s_lshl_b32 s100, s100, 15
  s_add_u32 s100, s100, s7
  v_dot2_f32_bf16 v24, v48, v12, 0
  v_dot2_f32_bf16 v25, v52, v12, 0
  v_dot2_f32_bf16 v26, v56, v12, 0
  v_dot2_f32_bf16 v27, v60, v12, 0
  v_dot2_f32_bf16 v24, v49, v13, v24
  v_dot2_f32_bf16 v25, v53, v13, v25
  v_dot2_f32_bf16 v26, v57, v13, v26
  v_dot2_f32_bf16 v27, v61, v13, v27
  v_dot2_f32_bf16 v24, v50, v14, v24
  v_dot2_f32_bf16 v25, v54, v14, v25
  v_dot2_f32_bf16 v26, v58, v14, v26
  v_dot2_f32_bf16 v27, v62, v14, v27
  v_dot2_f32_bf16 v24, v51, v15, v24
  v_dot2_f32_bf16 v25, v55, v15, v25
  v_dot2_f32_bf16 v26, v59, v15, v26
  v_dot2_f32_bf16 v27, v63, v15, v27
  buffer_load_dwordx4 v[48:51], v4, s[40:43], s100 offen offset:0 nt
  buffer_load_dwordx4 v[52:55], v4, s[40:43], s100 offen offset:1024 nt
  buffer_load_dwordx4 v[56:59], v4, s[40:43], s100 offen offset:2048 nt
  buffer_load_dwordx4 v[60:63], v4, s[40:43], s100 offen offset:3072 nt
  v_add_f32_dpp v30, v24, v24 row_ror:8 row_mask:0xf bank_mask:0x3
  s_nop 1
  v_add_f32_dpp v30, v25, v25 row_ror:8 row_mask:0xf bank_mask:0xc
  v_add_f32_dpp v31, v26, v26 row_ror:8 row_mask:0xf bank_mask:0x3
  s_nop 1
  v_add_f32_dpp v31, v27, v27 row_ror:8 row_mask:0xf bank_mask:0xc
  v_add_f32_dpp v32, v30, v30 row_shl:4 row_mask:0xf bank_mask:0x5
  s_nop 1
  v_add_f32_dpp v32, v31, v31 row_shr:4 row_mask:0xf bank_mask:0xa
  s_nop 1
  v_add_f32_dpp v32, v32, v32 quad_perm:[1,0,3,2] row_mask:0xf bank_mask:0xf
  s_nop 1
  v_add_f32_dpp v32, v32, v32 quad_perm:[2,3,0,1] row_mask:0xf bank_mask:0xf
  v_cvt_pk_bf16_f32 v32, v32, v32
  v_and_b32 v32, 0xffff0000, v32
  v_mul_f32 v32, 0x3db504f3, v32
  v_cvt_pk_bf16_f32 v32, v32, v32
  v_and_b32 v32, 0xffff0000, v32
  s_nop 1
  v_max_f32_dpp v33, v32, v32 row_ror:4 row_mask:0xf bank_mask:0xf
  s_nop 1
  v_max_f32_dpp v33, v33, v33 row_ror:8 row_mask:0xf bank_mask:0xf
  v_max_f32 v33, v33, v28
  v_cmp_gt_f32 vcc, v33, v28
  s_cbranch_vccz L_skip_16
  v_sub_f32 v37, v28, v33
  v_mul_f32 v37, 0x3fb8aa3b, v37
  v_exp_f32 v37, v37
  v_mov_b32 v28, v33
  v_mul_f32 v16, v16, v37
  v_mul_f32 v17, v17, v37
  v_mul_f32 v18, v18, v37
  v_mul_f32 v19, v19, v37
  v_mul_f32 v20, v20, v37
  v_mul_f32 v21, v21, v37
  v_mul_f32 v22, v22, v37
  v_mul_f32 v23, v23, v37
  v_mul_f32 v29, v29, v37
L_skip_16:
  v_sub_f32 v34, v32, v28
  v_mul_f32 v34, 0x3fb8aa3b, v34
  v_exp_f32 v34, v34
  s_nop 0
  v_cvt_pk_bf16_f32 v35, v34, 0
  v_cvt_pk_bf16_f32 v36, 0, v34
  v_add_f32 v29, v29, v36
  s_waitcnt vmcnt(22)
  v_dot2c_f32_bf16_dpp v16, v35, v80 row_newbcast:0 row_mask:0xf bank_mask:0xf
  v_dot2c_f32_bf16_dpp v17, v36, v80 row_newbcast:0 row_mask:0xf bank_mask:0xf
  v_dot2c_f32_bf16_dpp v18, v35, v81 row_newbcast:0 row_mask:0xf bank_mask:0xf
  v_dot2c_f32_bf16_dpp v19, v36, v81 row_newbcast:0 row_mask:0xf bank_mask:0xf
  v_dot2c_f32_bf16_dpp v20, v35, v82 row_newbcast:0 row_mask:0xf bank_mask:0xf
  v_dot2c_f32_bf16_dpp v21, v36, v82 row_newbcast:0 row_mask:0xf bank_mask:0xf
  v_dot2c_f32_bf16_dpp v22, v35, v83 row_newbcast:0 row_mask:0xf bank_mask:0xf
  v_dot2c_f32_bf16_dpp v23, v36, v83 row_newbcast:0 row_mask:0xf bank_mask:0xf
  v_dot2c_f32_bf16_dpp v16, v35, v84 row_newbcast:8 row_mask:0xf bank_mask:0xf
  v_dot2c_f32_bf16_dpp v17, v36, v84 row_newbcast:8 row_mask:0xf bank_mask:0xf
  v_dot2c_f32_bf16_dpp v18, v35, v85 row_newbcast:8 row_mask:0xf bank_mask:0xf
  v_dot2c_f32_bf16_dpp v19, v36, v85 row_newbcast:8 row_mask:0xf bank_mask:0xf
  v_dot2c_f32_bf16_dpp v20, v35, v86 row_newbcast:8 row_mask:0xf bank_mask:0xf
  v_dot2c_f32_bf16_dpp v21, v36, v86 row_newbcast:8 row_mask:0xf bank_mask:0xf
  v_dot2c_f32_bf16_dpp v22, v35, v87 row_newbcast:8 row_mask:0xf bank_mask:0xf
  v_dot2c_f32_bf16_dpp v23, v36, v87 row_newbcast:8 row_mask:0xf bank_mask:0xf
  v_dot2c_f32_bf16_dpp v16, v35, v88 row_newbcast:4 row_mask:0xf bank_mask:0xf
  v_dot2c_f32_bf16_dpp v17, v36, v88 row_newbcast:4 row_mask:0xf bank_mask:0xf
  v_dot2c_f32_bf16_dpp v18, v35, v89 row_newbcast:4 row_mask:0xf bank_mask:0xf
  v_dot2c_f32_bf16_dpp v19, v36, v89 row_newbcast:4 row_mask:0xf bank_mask:0xf
  v_dot2c_f32_bf16_dpp v20, v35, v90 row_newbcast:4 row_mask:0xf bank_mask:0xf
  v_dot2c_f32_bf16_dpp v21, v36, v90 row_newbcast:4 row_mask:0xf bank_mask:0xf
  v_dot2c_f32_bf16_dpp v22, v35, v91 row_newbcast:4 row_mask:0xf bank_mask:0xf
  v_dot2c_f32_bf16_dpp v23, v36, v91 row_newbcast:4 row_mask:0xf bank_mask:0xf
  v_dot2c_f32_bf16_dpp v16, v35, v92 row_newbcast:12 row_mask:0xf bank_mask:0xf
  v_dot2c_f32_bf16_dpp v17, v36, v92 row_newbcast:12 row_mask:0xf bank_mask:0xf
  v_dot2c_f32_bf16_dpp v18, v35, v93 row_newbcast:12 row_mask:0xf bank_mask:0xf
  v_dot2c_f32_bf16_dpp v19, v36, v93 row_newbcast:12 row_mask:0xf bank_mask:0xf
  v_dot2c_f32_bf16_dpp v20, v35, v94 row_newbcast:12 row_mask:0xf bank_mask:0xf
  v_dot2c_f32_bf16_dpp v21, v36, v94 row_newbcast:12 row_mask:0xf bank_mask:0xf
  v_dot2c_f32_bf16_dpp v22, v35, v95 row_newbcast:12 row_mask:0xf bank_mask:0xf
  v_dot2c_f32_bf16_dpp v23, v36, v95 row_newbcast:12 row_mask:0xf bank_mask:0xf
  buffer_load_dwordx4 v[80:83], v4, s[44:47], s100 offen offset:0 nt
  buffer_load_dwordx4 v[84:87], v4, s[44:47], s100 offen offset:1024 nt
  buffer_load_dwordx4 v[88:91], v4, s[44:47], s100 offen offset:2048 nt
  buffer_load_dwordx4 v[92:95], v4, s[44:47], s100 offen offset:3072 nt
  s_waitcnt vmcnt(17)
  s_add_u32 s100, s11, 14
  s_and_b32 s100, s100, 15
  s_lshl_b32 s100, s100, 15
  s_add_u32 s100, s100, s7
  v_dot2_f32_bf16 v24, v64, v12, 0
  v_dot2_f32_bf16 v25, v68, v12, 0
  v_dot2_f32_bf16 v26, v72, v12, 0
  v_dot2_f32_bf16 v27, v76, v12, 0
  v_dot2_f32_bf16 v24, v65, v13, v24
  v_dot2_f32_bf16 v25, v69, v13, v25
  v_dot2_f32_bf16 v26, v73, v13, v26
  v_dot2_f32_bf16 v27, v77, v13, v27
  v_dot2_f32_bf16 v24, v66, v14, v24
  v_dot2_f32_bf16 v25, v70, v14, v25
  v_dot2_f32_bf16 v26, v74, v14, v26
  v_dot2_f32_bf16 v27, v78, v14, v27
  v_dot2_f32_bf16 v24, v67, v15, v24
  v_dot2_f32_bf16 v25, v71, v15, v25
  v_dot2_f32_bf16 v26, v75, v15, v26
  v_dot2_f32_bf16 v27, v79, v15, v27
  buffer_load_dwordx4 v[64:67], v4, s[40:43], s100 offen offset:0 nt
  buffer_load_dwordx4 v[68:71], v4, s[40:43], s100 offen offset:1024 nt
  buffer_load_dwordx4 v[72:75], v4, s[40:43], s100 offen offset:2048 nt
  buffer_load_dwordx4 v[76:79], v4, s[40:43], s100 offen offset:3072 nt
  v_add_f32_dpp v30, v24, v24 row_ror:8 row_mask:0xf bank_mask:0x3
  s_nop 1
  v_add_f32_dpp v30, v25, v25 row_ror:8 row_mask:0xf bank_mask:0xc
  v_add_f32_dpp v31, v26, v26 row_ror:8 row_mask:0xf bank_mask:0x3
  s_nop 1
  v_add_f32_dpp v31, v27, v27 row_ror:8 row_mask:0xf bank_mask:0xc
  v_add_f32_dpp v32, v30, v30 row_shl:4 row_mask:0xf bank_mask:0x5
  s_nop 1
  v_add_f32_dpp v32, v31, v31 row_shr:4 row_mask:0xf bank_mask:0xa
  s_nop 1
  v_add_f32_dpp v32, v32, v32 quad_perm:[1,0,3,2] row_mask:0xf bank_mask:0xf
  s_nop 1
  v_add_f32_dpp v32, v32, v32 quad_perm:[2,3,0,1] row_mask:0xf bank_mask:0xf
  v_cvt_pk_bf16_f32 v32, v32, v32
  v_and_b32 v32, 0xffff0000, v32
  v_mul_f32 v32, 0x3db504f3, v32
  v_cvt_pk_bf16_f32 v32, v32, v32
  v_and_b32 v32, 0xffff0000, v32
  s_nop 1
  v_max_f32_dpp v33, v32, v32 row_ror:4 row_mask:0xf bank_mask:0xf
  s_nop 1
  v_max_f32_dpp v33, v33, v33 row_ror:8 row_mask:0xf bank_mask:0xf
  v_max_f32 v33, v33, v28
  v_cmp_gt_f32 vcc, v33, v28
  s_cbranch_vccz L_skip_17
  v_sub_f32 v37, v28, v33
  v_mul_f32 v37, 0x3fb8aa3b, v37
  v_exp_f32 v37, v37
  v_mov_b32 v28, v33
  v_mul_f32 v16, v16, v37
  v_mul_f32 v17, v17, v37
  v_mul_f32 v18, v18, v37
  v_mul_f32 v19, v19, v37
  v_mul_f32 v20, v20, v37
  v_mul_f32 v21, v21, v37
  v_mul_f32 v22, v22, v37
  v_mul_f32 v23, v23, v37
  v_mul_f32 v29, v29, v37
L_skip_17:
  v_sub_f32 v34, v32, v28
  v_mul_f32 v34, 0x3fb8aa3b, v34
  v_exp_f32 v34, v34
  s_nop 0
  v_cvt_pk_bf16_f32 v35, v34, 0
  v_cvt_pk_bf16_f32 v36, 0, v34
  v_add_f32 v29, v29, v36
  s_waitcnt vmcnt(17)
  v_dot2c_f32_bf16_dpp v16, v35, v96 row_newbcast:0 row_mask:0xf bank_mask:0xf
  v_dot2c_f32_bf16_dpp v17, v36, v96 row_newbcast:0 row_mask:0xf bank_mask:0xf
  v_dot2c_f32_bf16_dpp v18, v35, v97 row_newbcast:0 row_mask:0xf bank_mask:0xf
  v_dot2c_f32_bf16_dpp v19, v36, v97 row_newbcast:0 row_mask:0xf bank_mask:0xf
  v_dot2c_f32_bf16_dpp v20, v35, v98 row_newbcast:0 row_mask:0xf bank_mask:0xf
  v_dot2c_f32_bf16_dpp v21, v36, v98 row_newbcast:0 row_mask:0xf bank_mask:0xf
  v_dot2c_f32_bf16_dpp v22, v35, v99 row_newbcast:0 row_mask:0xf bank_mask:0xf
  v_dot2c_f32_bf16_dpp v23, v36, v99 row_newbcast:0 row_mask:0xf bank_mask:0xf
  v_dot2c_f32_bf16_dpp v16, v35, v100 row_newbcast:8 row_mask:0xf bank_mask:0xf
  v_dot2c_f32_bf16_dpp v17, v36, v100 row_newbcast:8 row_mask:0xf bank_mask:0xf
  v_dot2c_f32_bf16_dpp v18, v35, v101 row_newbcast:8 row_mask:0xf bank_mask:0xf
  v_dot2c_f32_bf16_dpp v19, v36, v101 row_newbcast:8 row_mask:0xf bank_mask:0xf
  v_dot2c_f32_bf16_dpp v20, v35, v102 row_newbcast:8 row_mask:0xf bank_mask:0xf
  v_dot2c_f32_bf16_dpp v21, v36, v102 row_newbcast:8 row_mask:0xf bank_mask:0xf
  v_dot2c_f32_bf16_dpp v22, v35, v103 row_newbcast:8 row_mask:0xf bank_mask:0xf
  v_dot2c_f32_bf16_dpp v23, v36, v103 row_newbcast:8 row_mask:0xf bank_mask:0xf
  v_dot2c_f32_bf16_dpp v16, v35, v104 row_newbcast:4 row_mask:0xf bank_mask:0xf
  v_dot2c_f32_bf16_dpp v17, v36, v104 row_newbcast:4 row_mask:0xf bank_mask:0xf
  v_dot2c_f32_bf16_dpp v18, v35, v105 row_newbcast:4 row_mask:0xf bank_mask:0xf
  v_dot2c_f32_bf16_dpp v19, v36, v105 row_newbcast:4 row_mask:0xf bank_mask:0xf
  v_dot2c_f32_bf16_dpp v20, v35, v106 row_newbcast:4 row_mask:0xf bank_mask:0xf
  v_dot2c_f32_bf16_dpp v21, v36, v106 row_newbcast:4 row_mask:0xf bank_mask:0xf
  v_dot2c_f32_bf16_dpp v22, v35, v107 row_newbcast:4 row_mask:0xf bank_mask:0xf
  v_dot2c_f32_bf16_dpp v23, v36, v107 row_newbcast:4 row_mask:0xf bank_mask:0xf
  v_dot2c_f32_bf16_dpp v16, v35, v108 row_newbcast:12 row_mask:0xf bank_mask:0xf
  v_dot2c_f32_bf16_dpp v17, v36, v108 row_newbcast:12 row_mask:0xf bank_mask:0xf
  v_dot2c_f32_bf16_dpp v18, v35, v109 row_newbcast:12 row_mask:0xf bank_mask:0xf
  v_dot2c_f32_bf16_dpp v19, v36, v109 row_newbcast:12 row_mask:0xf bank_mask:0xf
  v_dot2c_f32_bf16_dpp v20, v35, v110 row_newbcast:12 row_mask:0xf bank_mask:0xf
  v_dot2c_f32_bf16_dpp v21, v36, v110 row_newbcast:12 row_mask:0xf bank_mask:0xf
  v_dot2c_f32_bf16_dpp v22, v35, v111 row_newbcast:12 row_mask:0xf bank_mask:0xf
  v_dot2c_f32_bf16_dpp v23, v36, v111 row_newbcast:12 row_mask:0xf bank_mask:0xf
  buffer_load_dwordx4 v[96:99], v4, s[44:47], s100 offen offset:0 nt
  buffer_load_dwordx4 v[100:103], v4, s[44:47], s100 offen offset:1024 nt
  buffer_load_dwordx4 v[104:107], v4, s[44:47], s100 offen offset:2048 nt
  buffer_load_dwordx4 v[108:111], v4, s[44:47], s100 offen offset:3072 nt
  s_waitcnt vmcnt(12)
  s_add_u32 s100, s11, 15
  s_and_b32 s100, s100, 15
  s_lshl_b32 s100, s100, 15
  s_add_u32 s100, s100, s7
  v_dot2_f32_bf16 v24, v48, v12, 0
  v_dot2_f32_bf16 v25, v52, v12, 0
  v_dot2_f32_bf16 v26, v56, v12, 0
  v_dot2_f32_bf16 v27, v60, v12, 0
  v_dot2_f32_bf16 v24, v49, v13, v24
  v_dot2_f32_bf16 v25, v53, v13, v25
  v_dot2_f32_bf16 v26, v57, v13, v26
  v_dot2_f32_bf16 v27, v61, v13, v27
  v_dot2_f32_bf16 v24, v50, v14, v24
  v_dot2_f32_bf16 v25, v54, v14, v25
  v_dot2_f32_bf16 v26, v58, v14, v26
  v_dot2_f32_bf16 v27, v62, v14, v27
  v_dot2_f32_bf16 v24, v51, v15, v24
  v_dot2_f32_bf16 v25, v55, v15, v25
  v_dot2_f32_bf16 v26, v59, v15, v26
  v_dot2_f32_bf16 v27, v63, v15, v27
  buffer_load_dwordx4 v[48:51], v4, s[40:43], s100 offen offset:0 nt
  buffer_load_dwordx4 v[52:55], v4, s[40:43], s100 offen offset:1024 nt
  buffer_load_dwordx4 v[56:59], v4, s[40:43], s100 offen offset:2048 nt
  buffer_load_dwordx4 v[60:63], v4, s[40:43], s100 offen offset:3072 nt
  v_add_f32_dpp v30, v24, v24 row_ror:8 row_mask:0xf bank_mask:0x3
  s_nop 1
  v_add_f32_dpp v30, v25, v25 row_ror:8 row_mask:0xf bank_mask:0xc
  v_add_f32_dpp v31, v26, v26 row_ror:8 row_mask:0xf bank_mask:0x3
  s_nop 1
  v_add_f32_dpp v31, v27, v27 row_ror:8 row_mask:0xf bank_mask:0xc
  v_add_f32_dpp v32, v30, v30 row_shl:4 row_mask:0xf bank_mask:0x5
  s_nop 1
  v_add_f32_dpp v32, v31, v31 row_shr:4 row_mask:0xf bank_mask:0xa
  s_nop 1
  v_add_f32_dpp v32, v32, v32 quad_perm:[1,0,3,2] row_mask:0xf bank_mask:0xf
  s_nop 1
  v_add_f32_dpp v32, v32, v32 quad_perm:[2,3,0,1] row_mask:0xf bank_mask:0xf
  v_cvt_pk_bf16_f32 v32, v32, v32
  v_and_b32 v32, 0xffff0000, v32
  v_mul_f32 v32, 0x3db504f3, v32
  v_cvt_pk_bf16_f32 v32, v32, v32
  v_and_b32 v32, 0xffff0000, v32
  s_nop 1
  v_max_f32_dpp v33, v32, v32 row_ror:4 row_mask:0xf bank_mask:0xf
  s_nop 1
  v_max_f32_dpp v33, v33, v33 row_ror:8 row_mask:0xf bank_mask:0xf
  v_max_f32 v33, v33, v28
  v_cmp_gt_f32 vcc, v33, v28
  s_cbranch_vccz L_skip_18
  v_sub_f32 v37, v28, v33
  v_mul_f32 v37, 0x3fb8aa3b, v37
  v_exp_f32 v37, v37
  v_mov_b32 v28, v33
  v_mul_f32 v16, v16, v37
  v_mul_f32 v17, v17, v37
  v_mul_f32 v18, v18, v37
  v_mul_f32 v19, v19, v37
  v_mul_f32 v20, v20, v37
  v_mul_f32 v21, v21, v37
  v_mul_f32 v22, v22, v37
  v_mul_f32 v23, v23, v37
  v_mul_f32 v29, v29, v37
L_skip_18:
  v_sub_f32 v34, v32, v28
  v_mul_f32 v34, 0x3fb8aa3b, v34
  v_exp_f32 v34, v34
  s_nop 0
  v_cvt_pk_bf16_f32 v35, v34, 0
  v_cvt_pk_bf16_f32 v36, 0, v34
  v_add_f32 v29, v29, v36
  s_waitcnt vmcnt(12)
  v_dot2c_f32_bf16_dpp v16, v35, v80 row_newbcast:0 row_mask:0xf bank_mask:0xf
  v_dot2c_f32_bf16_dpp v17, v36, v80 row_newbcast:0 row_mask:0xf bank_mask:0xf
  v_dot2c_f32_bf16_dpp v18, v35, v81 row_newbcast:0 row_mask:0xf bank_mask:0xf
  v_dot2c_f32_bf16_dpp v19, v36, v81 row_newbcast:0 row_mask:0xf bank_mask:0xf
  v_dot2c_f32_bf16_dpp v20, v35, v82 row_newbcast:0 row_mask:0xf bank_mask:0xf
  v_dot2c_f32_bf16_dpp v21, v36, v82 row_newbcast:0 row_mask:0xf bank_mask:0xf
  v_dot2c_f32_bf16_dpp v22, v35, v83 row_newbcast:0 row_mask:0xf bank_mask:0xf
  v_dot2c_f32_bf16_dpp v23, v36, v83 row_newbcast:0 row_mask:0xf bank_mask:0xf
  v_dot2c_f32_bf16_dpp v16, v35, v84 row_newbcast:8 row_mask:0xf bank_mask:0xf
  v_dot2c_f32_bf16_dpp v17, v36, v84 row_newbcast:8 row_mask:0xf bank_mask:0xf
  v_dot2c_f32_bf16_dpp v18, v35, v85 row_newbcast:8 row_mask:0xf bank_mask:0xf
  v_dot2c_f32_bf16_dpp v19, v36, v85 row_newbcast:8 row_mask:0xf bank_mask:0xf
  v_dot2c_f32_bf16_dpp v20, v35, v86 row_newbcast:8 row_mask:0xf bank_mask:0xf
  v_dot2c_f32_bf16_dpp v21, v36, v86 row_newbcast:8 row_mask:0xf bank_mask:0xf
  v_dot2c_f32_bf16_dpp v22, v35, v87 row_newbcast:8 row_mask:0xf bank_mask:0xf
  v_dot2c_f32_bf16_dpp v23, v36, v87 row_newbcast:8 row_mask:0xf bank_mask:0xf
  v_dot2c_f32_bf16_dpp v16, v35, v88 row_newbcast:4 row_mask:0xf bank_mask:0xf
  v_dot2c_f32_bf16_dpp v17, v36, v88 row_newbcast:4 row_mask:0xf bank_mask:0xf
  v_dot2c_f32_bf16_dpp v18, v35, v89 row_newbcast:4 row_mask:0xf bank_mask:0xf
  v_dot2c_f32_bf16_dpp v19, v36, v89 row_newbcast:4 row_mask:0xf bank_mask:0xf
  v_dot2c_f32_bf16_dpp v20, v35, v90 row_newbcast:4 row_mask:0xf bank_mask:0xf
  v_dot2c_f32_bf16_dpp v21, v36, v90 row_newbcast:4 row_mask:0xf bank_mask:0xf
  v_dot2c_f32_bf16_dpp v22, v35, v91 row_newbcast:4 row_mask:0xf bank_mask:0xf
  v_dot2c_f32_bf16_dpp v23, v36, v91 row_newbcast:4 row_mask:0xf bank_mask:0xf
  v_dot2c_f32_bf16_dpp v16, v35, v92 row_newbcast:12 row_mask:0xf bank_mask:0xf
  v_dot2c_f32_bf16_dpp v17, v36, v92 row_newbcast:12 row_mask:0xf bank_mask:0xf
  v_dot2c_f32_bf16_dpp v18, v35, v93 row_newbcast:12 row_mask:0xf bank_mask:0xf
  v_dot2c_f32_bf16_dpp v19, v36, v93 row_newbcast:12 row_mask:0xf bank_mask:0xf
  v_dot2c_f32_bf16_dpp v20, v35, v94 row_newbcast:12 row_mask:0xf bank_mask:0xf
  v_dot2c_f32_bf16_dpp v21, v36, v94 row_newbcast:12 row_mask:0xf bank_mask:0xf
  v_dot2c_f32_bf16_dpp v22, v35, v95 row_newbcast:12 row_mask:0xf bank_mask:0xf
  v_dot2c_f32_bf16_dpp v23, v36, v95 row_newbcast:12 row_mask:0xf bank_mask:0xf
  buffer_load_dwordx4 v[80:83], v4, s[44:47], s100 offen offset:0 nt
  buffer_load_dwordx4 v[84:87], v4, s[44:47], s100 offen offset:1024 nt
  buffer_load_dwordx4 v[88:91], v4, s[44:47], s100 offen offset:2048 nt
  buffer_load_dwordx4 v[92:95], v4, s[44:47], s100 offen offset:3072 nt
  s_waitcnt vmcnt(12)
  s_mov_b32 s60, 0x05040100
  s_mov_b32 s61, 0x07060302
  v_perm_b32 v40, v132, v112, s60
  v_perm_b32 v132, v132, v112, s61
  v_perm_b32 v112, v133, v113, s60
  v_perm_b32 v133, v133, v113, s61
  v_perm_b32 v113, v134, v114, s60
  v_perm_b32 v134, v134, v114, s61
  v_perm_b32 v114, v135, v115, s60
  v_perm_b32 v135, v135, v115, s61
  v_perm_b32 v115, v136, v116, s60
  v_perm_b32 v136, v136, v116, s61
  v_perm_b32 v116, v137, v117, s60
  v_perm_b32 v137, v137, v117, s61
  v_perm_b32 v117, v138, v118, s60
  v_perm_b32 v138, v138, v118, s61
  v_perm_b32 v118, v139, v119, s60
  v_perm_b32 v139, v139, v119, s61
  v_perm_b32 v119, v140, v120, s60
  v_perm_b32 v140, v140, v120, s61
  v_perm_b32 v120, v141, v121, s60
  v_perm_b32 v141, v141, v121, s61
  v_perm_b32 v121, v142, v122, s60
  v_perm_b32 v142, v142, v122, s61
  v_perm_b32 v122, v143, v123, s60
  v_perm_b32 v143, v143, v123, s61
  v_perm_b32 v123, v144, v124, s60
  v_perm_b32 v144, v144, v124, s61
  v_perm_b32 v124, v145, v125, s60
  v_perm_b32 v145, v145, v125, s61
  v_perm_b32 v125, v146, v126, s60
  v_perm_b32 v146, v146, v126, s61
  v_perm_b32 v126, v147, v127, s60
  v_perm_b32 v147, v147, v127, s61
  v_perm_b32 v127, v148, v128, s60
  v_perm_b32 v148, v148, v128, s61
  v_perm_b32 v128, v149, v129, s60
  v_perm_b32 v149, v149, v129, s61
  v_perm_b32 v129, v150, v130, s60
  v_perm_b32 v150, v150, v130, s61
  v_perm_b32 v130, v151, v131, s60
  v_perm_b32 v151, v151, v131, s61
  v_perm_b32 v131, v172, v152, s60
  v_perm_b32 v172, v172, v152, s61
  v_perm_b32 v152, v173, v153, s60
  v_perm_b32 v173, v173, v153, s61
  v_perm_b32 v153, v174, v154, s60
  v_perm_b32 v174, v174, v154, s61
  v_perm_b32 v154, v175, v155, s60
  v_perm_b32 v175, v175, v155, s61
  v_perm_b32 v155, v176, v156, s60
  v_perm_b32 v176, v176, v156, s61
  v_perm_b32 v156, v177, v157, s60
  v_perm_b32 v177, v177, v157, s61
  v_perm_b32 v157, v178, v158, s60
  v_perm_b32 v178, v178, v158, s61
  v_perm_b32 v158, v179, v159, s60
  v_perm_b32 v179, v179, v159, s61
  v_perm_b32 v159, v180, v160, s60
  v_perm_b32 v180, v180, v160, s61
  v_perm_b32 v160, v181, v161, s60
  v_perm_b32 v181, v181, v161, s61
  v_perm_b32 v161, v182, v162, s60
  v_perm_b32 v182, v182, v162, s61
  v_perm_b32 v162, v183, v163, s60
  v_perm_b32 v183, v183, v163, s61
  v_perm_b32 v163, v184, v164, s60
  v_perm_b32 v184, v184, v164, s61
  v_perm_b32 v164, v185, v165, s60
  v_perm_b32 v185, v185, v165, s61
  v_perm_b32 v165, v186, v166, s60
  v_perm_b32 v186, v186, v166, s61
  v_perm_b32 v166, v187, v167, s60
  v_perm_b32 v187, v187, v167, s61
  v_perm_b32 v167, v188, v168, s60
  v_perm_b32 v188, v188, v168, s61
  v_perm_b32 v168, v189, v169, s60
  v_perm_b32 v189, v189, v169, s61
  v_perm_b32 v169, v190, v170, s60
  v_perm_b32 v190, v190, v170, s61
  v_perm_b32 v170, v191, v171, s60
  v_perm_b32 v191, v191, v171, s61
  v_mov_b32 v6, 128
  v_mov_b32 v7, 0x7ffffff0
  v_cmp_eq_u32 vcc, 0x1c0, v0
  s_nop 1
  v_cndmask_b32 v6, v7, v6, vcc
  v_mov_b32 v42, 1
  buffer_atomic_add v42, v6, s[88:91], 0 offen sc0 sc1
  v_dot2_f32_bf16 v24, v64, v12, 0
  v_dot2_f32_bf16 v25, v68, v12, 0
  v_dot2_f32_bf16 v26, v72, v12, 0
  v_dot2_f32_bf16 v27, v76, v12, 0
  v_dot2_f32_bf16 v24, v65, v13, v24
  v_dot2_f32_bf16 v25, v69, v13, v25
  v_dot2_f32_bf16 v26, v73, v13, v26
  v_dot2_f32_bf16 v27, v77, v13, v27
  v_dot2_f32_bf16 v24, v66, v14, v24
  v_dot2_f32_bf16 v25, v70, v14, v25
  v_dot2_f32_bf16 v26, v74, v14, v26
  v_dot2_f32_bf16 v27, v78, v14, v27
  v_dot2_f32_bf16 v24, v67, v15, v24
  v_dot2_f32_bf16 v25, v71, v15, v25
  v_dot2_f32_bf16 v26, v75, v15, v26
  v_dot2_f32_bf16 v27, v79, v15, v27
  v_add_f32_dpp v30, v24, v24 row_ror:8 row_mask:0xf bank_mask:0x3
  s_nop 1
  v_add_f32_dpp v30, v25, v25 row_ror:8 row_mask:0xf bank_mask:0xc
  v_add_f32_dpp v31, v26, v26 row_ror:8 row_mask:0xf bank_mask:0x3
  s_nop 1
  v_add_f32_dpp v31, v27, v27 row_ror:8 row_mask:0xf bank_mask:0xc
  v_add_f32_dpp v32, v30, v30 row_shl:4 row_mask:0xf bank_mask:0x5
  s_nop 1
  v_add_f32_dpp v32, v31, v31 row_shr:4 row_mask:0xf bank_mask:0xa
  s_nop 1
  v_add_f32_dpp v32, v32, v32 quad_perm:[1,0,3,2] row_mask:0xf bank_mask:0xf
  s_nop 1
  v_add_f32_dpp v32, v32, v32 quad_perm:[2,3,0,1] row_mask:0xf bank_mask:0xf
  v_cvt_pk_bf16_f32 v32, v32, v32
  v_and_b32 v32, 0xffff0000, v32
  v_mul_f32 v32, 0x3db504f3, v32
  v_cvt_pk_bf16_f32 v32, v32, v32
  v_and_b32 v32, 0xffff0000, v32
  s_nop 1
  v_max_f32_dpp v33, v32, v32 row_ror:4 row_mask:0xf bank_mask:0xf
  s_nop 1
  v_max_f32_dpp v33, v33, v33 row_ror:8 row_mask:0xf bank_mask:0xf
  v_max_f32 v33, v33, v28
  v_cmp_gt_f32 vcc, v33, v28
  s_cbranch_vccz L_skip_19
  v_sub_f32 v37, v28, v33
  v_mul_f32 v37, 0x3fb8aa3b, v37
  v_exp_f32 v37, v37
  v_mov_b32 v28, v33
  v_mul_f32 v16, v16, v37
  v_mul_f32 v17, v17, v37
  v_mul_f32 v18, v18, v37
  v_mul_f32 v19, v19, v37
  v_mul_f32 v20, v20, v37
  v_mul_f32 v21, v21, v37
  v_mul_f32 v22, v22, v37
  v_mul_f32 v23, v23, v37
  v_mul_f32 v29, v29, v37
L_skip_19:
  v_sub_f32 v34, v32, v28
  v_mul_f32 v34, 0x3fb8aa3b, v34
  v_exp_f32 v34, v34
  s_nop 0
  v_cvt_pk_bf16_f32 v35, v34, 0
  v_cvt_pk_bf16_f32 v36, 0, v34
  v_add_f32 v29, v29, v36
  s_waitcnt vmcnt(9)
  v_dot2c_f32_bf16_dpp v16, v35, v96 row_newbcast:0 row_mask:0xf bank_mask:0xf
  v_dot2c_f32_bf16_dpp v17, v36, v96 row_newbcast:0 row_mask:0xf bank_mask:0xf
  v_dot2c_f32_bf16_dpp v18, v35, v97 row_newbcast:0 row_mask:0xf bank_mask:0xf
  v_dot2c_f32_bf16_dpp v19, v36, v97 row_newbcast:0 row_mask:0xf bank_mask:0xf
  v_dot2c_f32_bf16_dpp v20, v35, v98 row_newbcast:0 row_mask:0xf bank_mask:0xf
  v_dot2c_f32_bf16_dpp v21, v36, v98 row_newbcast:0 row_mask:0xf bank_mask:0xf
  v_dot2c_f32_bf16_dpp v22, v35, v99 row_newbcast:0 row_mask:0xf bank_mask:0xf
  v_dot2c_f32_bf16_dpp v23, v36, v99 row_newbcast:0 row_mask:0xf bank_mask:0xf
  v_dot2c_f32_bf16_dpp v16, v35, v100 row_newbcast:8 row_mask:0xf bank_mask:0xf
  v_dot2c_f32_bf16_dpp v17, v36, v100 row_newbcast:8 row_mask:0xf bank_mask:0xf
  v_dot2c_f32_bf16_dpp v18, v35, v101 row_newbcast:8 row_mask:0xf bank_mask:0xf
  v_dot2c_f32_bf16_dpp v19, v36, v101 row_newbcast:8 row_mask:0xf bank_mask:0xf
  v_dot2c_f32_bf16_dpp v20, v35, v102 row_newbcast:8 row_mask:0xf bank_mask:0xf
  v_dot2c_f32_bf16_dpp v21, v36, v102 row_newbcast:8 row_mask:0xf bank_mask:0xf
  v_dot2c_f32_bf16_dpp v22, v35, v103 row_newbcast:8 row_mask:0xf bank_mask:0xf
  v_dot2c_f32_bf16_dpp v23, v36, v103 row_newbcast:8 row_mask:0xf bank_mask:0xf
  v_dot2c_f32_bf16_dpp v16, v35, v104 row_newbcast:4 row_mask:0xf bank_mask:0xf
  v_dot2c_f32_bf16_dpp v17, v36, v104 row_newbcast:4 row_mask:0xf bank_mask:0xf
  v_dot2c_f32_bf16_dpp v18, v35, v105 row_newbcast:4 row_mask:0xf bank_mask:0xf
  v_dot2c_f32_bf16_dpp v19, v36, v105 row_newbcast:4 row_mask:0xf bank_mask:0xf
  v_dot2c_f32_bf16_dpp v20, v35, v106 row_newbcast:4 row_mask:0xf bank_mask:0xf
  v_dot2c_f32_bf16_dpp v21, v36, v106 row_newbcast:4 row_mask:0xf bank_mask:0xf
  v_dot2c_f32_bf16_dpp v22, v35, v107 row_newbcast:4 row_mask:0xf bank_mask:0xf
  v_dot2c_f32_bf16_dpp v23, v36, v107 row_newbcast:4 row_mask:0xf bank_mask:0xf
  v_dot2c_f32_bf16_dpp v16, v35, v108 row_newbcast:12 row_mask:0xf bank_mask:0xf
  v_dot2c_f32_bf16_dpp v17, v36, v108 row_newbcast:12 row_mask:0xf bank_mask:0xf
  v_dot2c_f32_bf16_dpp v18, v35, v109 row_newbcast:12 row_mask:0xf bank_mask:0xf
  v_dot2c_f32_bf16_dpp v19, v36, v109 row_newbcast:12 row_mask:0xf bank_mask:0xf
  v_dot2c_f32_bf16_dpp v20, v35, v110 row_newbcast:12 row_mask:0xf bank_mask:0xf
  v_dot2c_f32_bf16_dpp v21, v36, v110 row_newbcast:12 row_mask:0xf bank_mask:0xf
  v_dot2c_f32_bf16_dpp v22, v35, v111 row_newbcast:12 row_mask:0xf bank_mask:0xf
  v_dot2c_f32_bf16_dpp v23, v36, v111 row_newbcast:12 row_mask:0xf bank_mask:0xf
  s_waitcnt vmcnt(5)
  v_dot2_f32_bf16 v24, v48, v12, 0
  v_dot2_f32_bf16 v25, v52, v12, 0
  v_dot2_f32_bf16 v26, v56, v12, 0
  v_dot2_f32_bf16 v27, v60, v12, 0
  v_dot2_f32_bf16 v24, v49, v13, v24
  v_dot2_f32_bf16 v25, v53, v13, v25
  v_dot2_f32_bf16 v26, v57, v13, v26
  v_dot2_f32_bf16 v27, v61, v13, v27
  v_dot2_f32_bf16 v24, v50, v14, v24
  v_dot2_f32_bf16 v25, v54, v14, v25
  v_dot2_f32_bf16 v26, v58, v14, v26
  v_dot2_f32_bf16 v27, v62, v14, v27
  v_dot2_f32_bf16 v24, v51, v15, v24
  v_dot2_f32_bf16 v25, v55, v15, v25
  v_dot2_f32_bf16 v26, v59, v15, v26
  v_dot2_f32_bf16 v27, v63, v15, v27
  v_add_f32_dpp v30, v24, v24 row_ror:8 row_mask:0xf bank_mask:0x3
  s_nop 1
  v_add_f32_dpp v30, v25, v25 row_ror:8 row_mask:0xf bank_mask:0xc
  v_add_f32_dpp v31, v26, v26 row_ror:8 row_mask:0xf bank_mask:0x3
  s_nop 1
  v_add_f32_dpp v31, v27, v27 row_ror:8 row_mask:0xf bank_mask:0xc
  v_add_f32_dpp v32, v30, v30 row_shl:4 row_mask:0xf bank_mask:0x5
  s_nop 1
  v_add_f32_dpp v32, v31, v31 row_shr:4 row_mask:0xf bank_mask:0xa
  s_nop 1
  v_add_f32_dpp v32, v32, v32 quad_perm:[1,0,3,2] row_mask:0xf bank_mask:0xf
  s_nop 1
  v_add_f32_dpp v32, v32, v32 quad_perm:[2,3,0,1] row_mask:0xf bank_mask:0xf
  v_cvt_pk_bf16_f32 v32, v32, v32
  v_and_b32 v32, 0xffff0000, v32
  v_mul_f32 v32, 0x3db504f3, v32
  v_cvt_pk_bf16_f32 v32, v32, v32
  v_and_b32 v32, 0xffff0000, v32
  s_nop 1
  v_max_f32_dpp v33, v32, v32 row_ror:4 row_mask:0xf bank_mask:0xf
  s_nop 1
  v_max_f32_dpp v33, v33, v33 row_ror:8 row_mask:0xf bank_mask:0xf
  v_max_f32 v33, v33, v28
  v_cmp_gt_f32 vcc, v33, v28
  s_cbranch_vccz L_skip_20
  v_sub_f32 v37, v28, v33
  v_mul_f32 v37, 0x3fb8aa3b, v37
  v_exp_f32 v37, v37
  v_mov_b32 v28, v33
  v_mul_f32 v16, v16, v37
  v_mul_f32 v17, v17, v37
  v_mul_f32 v18, v18, v37
  v_mul_f32 v19, v19, v37
  v_mul_f32 v20, v20, v37
  v_mul_f32 v21, v21, v37
  v_mul_f32 v22, v22, v37
  v_mul_f32 v23, v23, v37
  v_mul_f32 v29, v29, v37
L_skip_20:
  v_sub_f32 v34, v32, v28
  v_mul_f32 v34, 0x3fb8aa3b, v34
  v_exp_f32 v34, v34
  s_nop 0
  v_cvt_pk_bf16_f32 v35, v34, 0
  v_cvt_pk_bf16_f32 v36, 0, v34
  v_add_f32 v29, v29, v36
  s_waitcnt vmcnt(1)
  v_dot2c_f32_bf16_dpp v16, v35, v80 row_newbcast:0 row_mask:0xf bank_mask:0xf
  v_dot2c_f32_bf16_dpp v17, v36, v80 row_newbcast:0 row_mask:0xf bank_mask:0xf
  v_dot2c_f32_bf16_dpp v18, v35, v81 row_newbcast:0 row_mask:0xf bank_mask:0xf
  v_dot2c_f32_bf16_dpp v19, v36, v81 row_newbcast:0 row_mask:0xf bank_mask:0xf
  v_dot2c_f32_bf16_dpp v20, v35, v82 row_newbcast:0 row_mask:0xf bank_mask:0xf
  v_dot2c_f32_bf16_dpp v21, v36, v82 row_newbcast:0 row_mask:0xf bank_mask:0xf
  v_dot2c_f32_bf16_dpp v22, v35, v83 row_newbcast:0 row_mask:0xf bank_mask:0xf
  v_dot2c_f32_bf16_dpp v23, v36, v83 row_newbcast:0 row_mask:0xf bank_mask:0xf
  v_dot2c_f32_bf16_dpp v16, v35, v84 row_newbcast:8 row_mask:0xf bank_mask:0xf
  v_dot2c_f32_bf16_dpp v17, v36, v84 row_newbcast:8 row_mask:0xf bank_mask:0xf
  v_dot2c_f32_bf16_dpp v18, v35, v85 row_newbcast:8 row_mask:0xf bank_mask:0xf
  v_dot2c_f32_bf16_dpp v19, v36, v85 row_newbcast:8 row_mask:0xf bank_mask:0xf
  v_dot2c_f32_bf16_dpp v20, v35, v86 row_newbcast:8 row_mask:0xf bank_mask:0xf
  v_dot2c_f32_bf16_dpp v21, v36, v86 row_newbcast:8 row_mask:0xf bank_mask:0xf
  v_dot2c_f32_bf16_dpp v22, v35, v87 row_newbcast:8 row_mask:0xf bank_mask:0xf
  v_dot2c_f32_bf16_dpp v23, v36, v87 row_newbcast:8 row_mask:0xf bank_mask:0xf
  v_dot2c_f32_bf16_dpp v16, v35, v88 row_newbcast:4 row_mask:0xf bank_mask:0xf
  v_dot2c_f32_bf16_dpp v17, v36, v88 row_newbcast:4 row_mask:0xf bank_mask:0xf
  v_dot2c_f32_bf16_dpp v18, v35, v89 row_newbcast:4 row_mask:0xf bank_mask:0xf
  v_dot2c_f32_bf16_dpp v19, v36, v89 row_newbcast:4 row_mask:0xf bank_mask:0xf
  v_dot2c_f32_bf16_dpp v20, v35, v90 row_newbcast:4 row_mask:0xf bank_mask:0xf
  v_dot2c_f32_bf16_dpp v21, v36, v90 row_newbcast:4 row_mask:0xf bank_mask:0xf
  v_dot2c_f32_bf16_dpp v22, v35, v91 row_newbcast:4 row_mask:0xf bank_mask:0xf
  v_dot2c_f32_bf16_dpp v23, v36, v91 row_newbcast:4 row_mask:0xf bank_mask:0xf
  v_dot2c_f32_bf16_dpp v16, v35, v92 row_newbcast:12 row_mask:0xf bank_mask:0xf
  v_dot2c_f32_bf16_dpp v17, v36, v92 row_newbcast:12 row_mask:0xf bank_mask:0xf
  v_dot2c_f32_bf16_dpp v18, v35, v93 row_newbcast:12 row_mask:0xf bank_mask:0xf
  v_dot2c_f32_bf16_dpp v19, v36, v93 row_newbcast:12 row_mask:0xf bank_mask:0xf
  v_dot2c_f32_bf16_dpp v20, v35, v94 row_newbcast:12 row_mask:0xf bank_mask:0xf
  v_dot2c_f32_bf16_dpp v21, v36, v94 row_newbcast:12 row_mask:0xf bank_mask:0xf
  v_dot2c_f32_bf16_dpp v22, v35, v95 row_newbcast:12 row_mask:0xf bank_mask:0xf
  v_dot2c_f32_bf16_dpp v23, v36, v95 row_newbcast:12 row_mask:0xf bank_mask:0xf
  s_waitcnt vmcnt(0)
  s_cmp_lg_u32 s3, 7
  s_cbranch_scc1 L_tkw
  v_mov_b32 v6, 0
  s_mov_b64 exec, 1
  ds_write_b32 v6, v42 offset:41988
  s_mov_b64 exec, -1
L_tkw:
  s_nop 3
  v_add_f32_dpp v29, v29, v29 row_ror:4 row_mask:0xf bank_mask:0xf
  v_mov_b32 v33, v28
  s_nop 0
  v_add_f32_dpp v29, v29, v29 row_ror:8 row_mask:0xf bank_mask:0xf
  v_mov_b32 v6, v33
  s_nop 1
  v_permlane32_swap_b32 v6, v33
  v_max_f32 v33, v6, v33
  v_mov_b32 v6, v33
  s_nop 1
  v_permlane16_swap_b32 v6, v33
  v_max_f32 v33, v6, v33
  v_sub_f32 v37, v28, v33
  v_mul_f32 v37, 0x3fb8aa3b, v37
  v_exp_f32 v37, v37
  s_lshl_b32 s8, s3, 9
  v_add_u32 v8, s8, v5
  v_mul_f32 v16, v16, v37
  v_mul_f32 v17, v17, v37
  v_mul_f32 v18, v18, v37
  v_mul_f32 v19, v19, v37
  v_mul_f32 v20, v20, v37
  v_mul_f32 v21, v21, v37
  v_mul_f32 v22, v22, v37
  v_mul_f32 v23, v23, v37
  v_mul_f32 v29, v29, v37
  v_permlane32_swap_b32 v16, v17
  v_permlane32_swap_b32 v18, v19
  v_permlane32_swap_b32 v20, v21
  v_permlane32_swap_b32 v22, v23
  v_add_f32 v16, v16, v17
  v_add_f32 v18, v18, v19
  v_add_f32 v20, v20, v21
  v_add_f32 v22, v22, v23
  v_permlane16_swap_b32 v16, v18
  s_nop 0
  v_permlane16_swap_b32 v20, v22
  v_add_f32 v16, v16, v18
  v_add_f32 v20, v20, v22
  ds_write_b32 v8, v16 offset:0
  ds_write_b32 v8, v20 offset:16
  v_mov_b32 v6, v29
  s_nop 1
  v_permlane32_swap_b32 v6, v29
  v_add_f32 v29, v6, v29
  v_mov_b32 v6, v29
  s_nop 1
  v_permlane16_swap_b32 v6, v29
  v_add_f32 v29, v6, v29
  s_lshl_b32 s8, s3, 3
  v_mov_b32 v6, s8
  v_mov_b32 v24, v33
  v_mov_b32 v25, v29
  ds_write_b64 v6, v[24:25] offset:4096
  v_mov_b32 v7, 0x7ffffff0
  s_waitcnt lgkmcnt(0)
  s_barrier
  v_mov_b32 v6, 0
  ds_read_b32 v8, v6 offset:41988
  s_waitcnt lgkmcnt(0)
  v_readfirstlane_b32 s93, v8
  s_nop 1
  s_and_b32 s93, s93, 255
  s_mov_b32 s66, s93
  s_sub_u32 s68, s93, 54
  s_cmp_lt_u32 s68, 80
  s_cselect_b32 s14, 2, 0
  s_cmp_lt_u32 s93, 54
  s_cselect_b32 s14, 1, s14
  s_cmp_ge_u32 s68, 40
  s_cselect_b32 s70, 1, 0
  s_mul_i32 s8, s70, 40
  s_sub_u32 s71, s68, s8
  s_cmp_lg_u32 s14, 1
  s_cbranch_scc1 L_nogu
  s_cmp_lt_u32 s3, 4
  s_cselect_b32 s72, s28, s30
  s_cselect_b32 s73, s29, s31
  s_mov_b32 s74, 0x21c000
  s_mov_b32 s75, 0x20000
  s_mov_b32 s96, s32
  s_mov_b32 s97, s33
  s_mov_b32 s98, 0x21c000
  s_mov_b32 s99, 0x20000
  v_lshrrev_b32 v6, 2, v1
  s_mul_i32 s8, s69, 160
  v_add_u32 v6, s8, v6
  v_mul_u32_u24 v38, 3456, v6
  v_and_b32 v7, 3, v1
  v_lshl_add_u32 v38, v7, 4, v38
  s_lshl_b32 s64, s66, 6
  buffer_load_dwordx4 v[208:211], v38, s[72:75], s64 offen
  s_add_u32 s64, s64, 55296
  buffer_load_dwordx4 v[212:215], v38, s[72:75], s64 offen
  s_add_u32 s64, s64, 55296
  buffer_load_dwordx4 v[216:219], v38, s[72:75], s64 offen
  s_add_u32 s64, s64, 55296
  buffer_load_dwordx4 v[220:223], v38, s[72:75], s64 offen
  s_add_u32 s64, s64, 55296
  buffer_load_dwordx4 v[224:227], v38, s[72:75], s64 offen
  s_add_u32 s64, s64, 55296
L_nogu:
  v_mov_b32 v6, 0
  ds_read_b128 v[48:51], v6 offset:4096
  ds_read_b128 v[52:55], v6 offset:4112
  ds_read_b128 v[56:59], v6 offset:4128
  ds_read_b128 v[60:63], v6 offset:4144
  ds_read_b128 v[192:195], v47 offset:0
  ds_read_b128 v[196:199], v47 offset:512
  ds_read_b128 v[200:203], v47 offset:1024
  ds_read_b128 v[204:207], v47 offset:1536
  ds_read_b128 v[16:19], v47 offset:2048
  ds_read_b128 v[20:23], v47 offset:2560
  ds_read_b128 v[12:15], v47 offset:3072
  ds_read_b128 v[24:27], v47 offset:3584
  s_mul_i32 s8, s3, 2560
  v_add_u32 v8, s8, v5
  s_mov_b32 s60, 0x3fb8aa3b
  s_waitcnt lgkmcnt(8)
  v_max3_f32 v28, v48, v50, v52
  v_max3_f32 v6, v54, v56, v58
  v_max3_f32 v28, v28, v60, v62
  v_max_f32 v28, v28, v6
  v_mul_f32 v7, 0x3fb8aa3b, v28
  v_fma_f32 v64, v48, s60, -v7
  v_fma_f32 v65, v50, s60, -v7
  v_fma_f32 v66, v52, s60, -v7
  v_fma_f32 v67, v54, s60, -v7
  v_fma_f32 v68, v56, s60, -v7
  v_fma_f32 v69, v58, s60, -v7
  v_fma_f32 v70, v60, s60, -v7
  v_fma_f32 v71, v62, s60, -v7
  v_exp_f32 v64, v64
  v_exp_f32 v65, v65
  v_exp_f32 v66, v66
  v_exp_f32 v67, v67
  v_exp_f32 v68, v68
  v_exp_f32 v69, v69
  v_exp_f32 v70, v70
  v_exp_f32 v71, v71
  s_waitcnt lgkmcnt(0)
  v_pk_mul_f32 v[24:25], v[24:25], v[70:71] op_sel:[0,1] op_sel_hi:[1,1]
  v_pk_mul_f32 v[26:27], v[26:27], v[70:71] op_sel:[0,1] op_sel_hi:[1,1]
  v_pk_fma_f32 v[24:25], v[192:193], v[64:65], v[24:25] op_sel:[0,0,0] op_sel_hi:[1,0,1]
  v_pk_fma_f32 v[26:27], v[194:195], v[64:65], v[26:27] op_sel:[0,0,0] op_sel_hi:[1,0,1]
  v_pk_fma_f32 v[24:25], v[196:197], v[64:65], v[24:25] op_sel:[0,1,0] op_sel_hi:[1,1,1]
  v_pk_fma_f32 v[26:27], v[198:199], v[64:65], v[26:27] op_sel:[0,1,0] op_sel_hi:[1,1,1]
  v_pk_fma_f32 v[24:25], v[200:201], v[66:67], v[24:25] op_sel:[0,0,0] op_sel_hi:[1,0,1]
  v_pk_fma_f32 v[26:27], v[202:203], v[66:67], v[26:27] op_sel:[0,0,0] op_sel_hi:[1,0,1]
  v_pk_fma_f32 v[24:25], v[204:205], v[66:67], v[24:25] op_sel:[0,1,0] op_sel_hi:[1,1,1]
  v_pk_fma_f32 v[26:27], v[206:207], v[66:67], v[26:27] op_sel:[0,1,0] op_sel_hi:[1,1,1]
  v_pk_fma_f32 v[24:25], v[16:17], v[68:69], v[24:25] op_sel:[0,0,0] op_sel_hi:[1,0,1]
  v_pk_fma_f32 v[26:27], v[18:19], v[68:69], v[26:27] op_sel:[0,0,0] op_sel_hi:[1,0,1]
  v_pk_fma_f32 v[24:25], v[20:21], v[68:69], v[24:25] op_sel:[0,1,0] op_sel_hi:[1,1,1]
  v_pk_fma_f32 v[26:27], v[22:23], v[68:69], v[26:27] op_sel:[0,1,0] op_sel_hi:[1,1,1]
  v_pk_fma_f32 v[24:25], v[12:13], v[70:71], v[24:25] op_sel:[0,0,0] op_sel_hi:[1,0,1]
  v_pk_fma_f32 v[26:27], v[14:15], v[70:71], v[26:27] op_sel:[0,0,0] op_sel_hi:[1,0,1]
  v_cvt_pk_bf16_f32 v16, v24, v25
  v_cvt_pk_bf16_f32 v17, v26, v27
  v_dot2_f32_bf16 v72, v40, v16, 0
  v_dot2_f32_bf16 v73, v132, v16, 0
  v_dot2_f32_bf16 v74, v112, v16, 0
  v_dot2_f32_bf16 v75, v133, v16, 0
  v_dot2_f32_bf16 v76, v113, v16, 0
  v_dot2_f32_bf16 v77, v134, v16, 0
  v_dot2_f32_bf16 v78, v114, v16, 0
  v_dot2_f32_bf16 v79, v135, v16, 0
  v_dot2_f32_bf16 v80, v115, v16, 0
  v_dot2_f32_bf16 v81, v136, v16, 0
  v_dot2_f32_bf16 v82, v116, v16, 0
  v_dot2_f32_bf16 v83, v137, v16, 0
  v_dot2_f32_bf16 v84, v117, v16, 0
  v_dot2_f32_bf16 v85, v138, v16, 0
  v_dot2_f32_bf16 v86, v118, v16, 0
  v_dot2_f32_bf16 v87, v139, v16, 0
  v_dot2_f32_bf16 v88, v119, v16, 0
  v_dot2_f32_bf16 v89, v140, v16, 0
  v_dot2_f32_bf16 v90, v120, v16, 0
  v_dot2_f32_bf16 v91, v141, v16, 0
  v_dot2_f32_bf16 v92, v121, v16, 0
  v_dot2_f32_bf16 v93, v142, v16, 0
  v_dot2_f32_bf16 v94, v122, v16, 0
  v_dot2_f32_bf16 v95, v143, v16, 0
  v_dot2_f32_bf16 v96, v123, v16, 0
  v_dot2_f32_bf16 v97, v144, v16, 0
  v_dot2_f32_bf16 v98, v124, v16, 0
  v_dot2_f32_bf16 v99, v145, v16, 0
  v_dot2_f32_bf16 v100, v125, v16, 0
  v_dot2_f32_bf16 v101, v146, v16, 0
  v_dot2_f32_bf16 v102, v126, v16, 0
  v_dot2_f32_bf16 v103, v147, v16, 0
  v_dot2_f32_bf16 v104, v127, v16, 0
  v_dot2_f32_bf16 v105, v148, v16, 0
  v_dot2_f32_bf16 v106, v128, v16, 0
  v_dot2_f32_bf16 v107, v149, v16, 0
  v_dot2_f32_bf16 v108, v129, v16, 0
  v_dot2_f32_bf16 v109, v150, v16, 0
  v_dot2_f32_bf16 v110, v130, v16, 0
  v_dot2_f32_bf16 v111, v151, v16, 0
  v_dot2_f32_bf16 v72, v131, v17, v72
  v_dot2_f32_bf16 v73, v172, v17, v73
  v_dot2_f32_bf16 v74, v152, v17, v74
  v_dot2_f32_bf16 v75, v173, v17, v75
  v_dot2_f32_bf16 v76, v153, v17, v76
  v_dot2_f32_bf16 v77, v174, v17, v77
  v_dot2_f32_bf16 v78, v154, v17, v78
  v_dot2_f32_bf16 v79, v175, v17, v79
  v_dot2_f32_bf16 v80, v155, v17, v80
  v_dot2_f32_bf16 v81, v176, v17, v81
  v_dot2_f32_bf16 v82, v156, v17, v82
  v_dot2_f32_bf16 v83, v177, v17, v83
  v_dot2_f32_bf16 v84, v157, v17, v84
  v_dot2_f32_bf16 v85, v178, v17, v85
  v_dot2_f32_bf16 v86, v158, v17, v86
  v_dot2_f32_bf16 v87, v179, v17, v87
  v_dot2_f32_bf16 v88, v159, v17, v88
  v_dot2_f32_bf16 v89, v180, v17, v89
  v_dot2_f32_bf16 v90, v160, v17, v90
  v_dot2_f32_bf16 v91, v181, v17, v91
  v_dot2_f32_bf16 v92, v161, v17, v92
  v_dot2_f32_bf16 v93, v182, v17, v93
  v_dot2_f32_bf16 v94, v162, v17, v94
  v_dot2_f32_bf16 v95, v183, v17, v95
  v_dot2_f32_bf16 v96, v163, v17, v96
  v_dot2_f32_bf16 v97, v184, v17, v97
  v_dot2_f32_bf16 v98, v164, v17, v98
  v_dot2_f32_bf16 v99, v185, v17, v99
  v_dot2_f32_bf16 v100, v165, v17, v100
  v_dot2_f32_bf16 v101, v186, v17, v101
  v_dot2_f32_bf16 v102, v166, v17, v102
  v_dot2_f32_bf16 v103, v187, v17, v103
  v_dot2_f32_bf16 v104, v167, v17, v104
  v_dot2_f32_bf16 v105, v188, v17, v105
  v_dot2_f32_bf16 v106, v168, v17, v106
  v_dot2_f32_bf16 v107, v189, v17, v107
  v_dot2_f32_bf16 v108, v169, v17, v108
  v_dot2_f32_bf16 v109, v190, v17, v109
  v_dot2_f32_bf16 v110, v170, v17, v110
  v_dot2_f32_bf16 v111, v191, v17, v111
  v_permlane32_swap_b32 v72, v73
  v_permlane32_swap_b32 v74, v75
  v_permlane32_swap_b32 v76, v77
  v_permlane32_swap_b32 v78, v79
  v_permlane32_swap_b32 v80, v81
  v_permlane32_swap_b32 v82, v83
  v_permlane32_swap_b32 v84, v85
  v_permlane32_swap_b32 v86, v87
  v_permlane32_swap_b32 v88, v89
  v_permlane32_swap_b32 v90, v91
  v_permlane32_swap_b32 v92, v93
  v_permlane32_swap_b32 v94, v95
  v_permlane32_swap_b32 v96, v97
  v_permlane32_swap_b32 v98, v99
  v_permlane32_swap_b32 v100, v101
  v_permlane32_swap_b32 v102, v103
  v_permlane32_swap_b32 v104, v105
  v_permlane32_swap_b32 v106, v107
  v_permlane32_swap_b32 v108, v109
  v_permlane32_swap_b32 v110, v111
  v_add_f32 v72, v72, v73
  v_add_f32 v74, v74, v75
  v_add_f32 v76, v76, v77
  v_add_f32 v78, v78, v79
  v_add_f32 v80, v80, v81
  v_add_f32 v82, v82, v83
  v_add_f32 v84, v84, v85
  v_add_f32 v86, v86, v87
  v_add_f32 v88, v88, v89
  v_add_f32 v90, v90, v91
  v_add_f32 v92, v92, v93
  v_add_f32 v94, v94, v95
  v_add_f32 v96, v96, v97
  v_add_f32 v98, v98, v99
  v_add_f32 v100, v100, v101
  v_add_f32 v102, v102, v103
  v_add_f32 v104, v104, v105
  v_add_f32 v106, v106, v107
  v_add_f32 v108, v108, v109
  v_add_f32 v110, v110, v111
  v_permlane16_swap_b32 v72, v74
  v_permlane16_swap_b32 v76, v78
  v_permlane16_swap_b32 v80, v82
  v_permlane16_swap_b32 v84, v86
  v_permlane16_swap_b32 v88, v90
  v_permlane16_swap_b32 v92, v94
  v_permlane16_swap_b32 v96, v98
  v_permlane16_swap_b32 v100, v102
  v_permlane16_swap_b32 v104, v106
  v_permlane16_swap_b32 v108, v110
  v_add_f32 v72, v72, v74
  v_add_f32 v76, v76, v78
  v_add_f32 v80, v80, v82
  v_add_f32 v84, v84, v86
  v_add_f32 v88, v88, v90
  v_add_f32 v92, v92, v94
  v_add_f32 v96, v96, v98
  v_add_f32 v100, v100, v102
  v_add_f32 v104, v104, v106
  v_add_f32 v108, v108, v110
  ds_write_b32 v8, v72 offset:4160
  ds_write_b32 v8, v76 offset:4176
  ds_write_b32 v8, v80 offset:4672
  ds_write_b32 v8, v84 offset:4688
  ds_write_b32 v8, v88 offset:5184
  ds_write_b32 v8, v92 offset:5200
  ds_write_b32 v8, v96 offset:5696
  ds_write_b32 v8, v100 offset:5712
  ds_write_b32 v8, v104 offset:6208
  ds_write_b32 v8, v108 offset:6224
  v_mul_f32 v29, v64, v49
  v_fmac_f32 v29, v65, v51
  v_fmac_f32 v29, v66, v53
  v_fmac_f32 v29, v67, v55
  v_fmac_f32 v29, v68, v57
  v_fmac_f32 v29, v69, v59
  v_fmac_f32 v29, v70, v61
  v_fmac_f32 v29, v71, v63
  v_mov_b32 v197, s13
  v_mov_b32 v199, s13
  v_mov_b32 v201, s13
  v_mov_b32 v203, s13
  v_mov_b32 v200, v28
  v_mov_b32 v202, v29
  s_lshl_b32 s8, s10, 12
  s_add_u32 s8, s8, 0x150000
  v_lshlrev_b32 v6, 4, v0
  v_mov_b32 v7, 0x7ffffff0
  v_cmp_gt_u32 vcc, 160, v0
  s_nop 1
  v_cndmask_b32 v192, v7, v6, vcc
  v_mov_b32 v193, 2560
  v_cmp_eq_u32 vcc, 0, v0
  s_nop 1
  v_cndmask_b32 v193, v7, v193, vcc
  buffer_store_dwordx4 v[200:203], v193, s[76:79], s8 offen sc1
  s_waitcnt lgkmcnt(0)
  s_barrier
  s_cmp_ge_u32 s3, 3
  s_cbranch_scc1 L_ydone
  ds_read_b128 v[48:51], v6 offset:4160
  ds_read_b128 v[52:55], v6 offset:6720
  ds_read_b128 v[56:59], v6 offset:9280
  ds_read_b128 v[60:63], v6 offset:11840
  ds_read_b128 v[64:67], v6 offset:14400
  ds_read_b128 v[68:71], v6 offset:16960
  ds_read_b128 v[72:75], v6 offset:19520
  ds_read_b128 v[76:79], v6 offset:22080
  s_waitcnt lgkmcnt(6)
  v_pk_add_f32 v[48:49], v[48:49], v[52:53]
  v_pk_add_f32 v[50:51], v[50:51], v[54:55]
  s_waitcnt lgkmcnt(4)
  v_pk_add_f32 v[56:57], v[56:57], v[60:61]
  v_pk_add_f32 v[58:59], v[58:59], v[62:63]
  s_waitcnt lgkmcnt(2)
  v_pk_add_f32 v[64:65], v[64:65], v[68:69]
  v_pk_add_f32 v[66:67], v[66:67], v[70:71]
  s_waitcnt lgkmcnt(0)
  v_pk_add_f32 v[72:73], v[72:73], v[76:77]
  v_pk_add_f32 v[74:75], v[74:75], v[78:79]
  v_pk_add_f32 v[48:49], v[48:49], v[56:57]
  v_pk_add_f32 v[64:65], v[64:65], v[72:73]
  v_pk_add_f32 v[50:51], v[50:51], v[58:59]
  v_pk_add_f32 v[66:67], v[66:67], v[74:75]
  v_pk_add_f32 v[48:49], v[48:49], v[64:65]
  v_pk_add_f32 v[50:51], v[50:51], v[66:67]
  v_cvt_pk_bf16_f32 v196, v48, v49
  v_cvt_pk_bf16_f32 v198, v50, v51
  buffer_store_dwordx4 v[196:199], v192, s[76:79], s8 offen sc1
  s_nop 4
L_ydone:
  s_cmp_eq_u32 s14, 0
  s_cbranch_scc1 L_fin
  s_cmp_eq_u32 s14, 1
  s_cbranch_scc1 L_ffn
  v_lshrrev_b32 v6, 4, v0
  v_mul_u32_u24 v50, 10240, v6
  v_lshl_add_u32 v50, v2, 4, v50
  s_lshl_b32 s9, s71, 8
  v_add_u32 v50, s9, v50
  v_lshrrev_b32 v6, 2, v0
  s_lshl_b32 s8, s70, 7
  v_add_u32 v6, s8, v6
  v_lshlrev_b32 v124, 12, v6
  v_and_b32 v7, 3, v0
  v_lshl_add_u32 v124, v7, 4, v124
  s_lshl_b32 s8, s71, 6
  s_add_u32 s8, s8, 0x150000
  v_add_u32 v124, s8, v124
  v_lshrrev_b32 v125, 1, v6
  v_lshlrev_b32 v125, 13, v125
  v_add_u32 v125, 0x150a00, v125
  v_and_b32 v8, 1, v6
  v_cmp_eq_u32 s[60:61], 1, v8
  s_mov_b32 s62, 4096
  v_lshl_add_u32 v131, v7, 2, v41
  v_lshlrev_b32 v131, 2, v131
  s_lshl_b32 s8, s3, 6
  v_add_u32 v131, s8, v131
  v_bfe_u32 v6, v0, 4, 1
  v_lshlrev_b32 v132, 8, v6
  v_lshl_add_u32 v132, v2, 2, v132
  v_bfe_u32 v6, v0, 4, 1
  v_mul_u32_u24 v6, 640, v6
  v_add_u32 v6, v6, v2
  s_mul_i32 s8, s70, 1280
  s_lshl_b32 s9, s71, 4
  s_add_u32 s8, s8, s9
  v_add_u32 v6, s8, v6
  v_lshlrev_b32 v52, 1, v6
  buffer_load_ushort v48, v52, s[56:59], 0 offen
  s_lshl_b32 s8, s68, 7
  s_add_u32 s8, s8, 0x42000
  v_lshlrev_b32 v51, 2, v0
  v_add_u32 v51, s8, v51
  v_mov_b32 v7, 0x7ffffff0
  v_cmp_gt_u32 vcc, 32, v0
  s_nop 1
  v_cndmask_b32 v52, v7, v52, vcc
  v_and_b32 v6, 0x1e3, v0
  v_cmp_eq_u32 vcc, 0, v6
  s_nop 1
  v_cndmask_b32 v51, v7, v51, vcc
  v_lshrrev_b32 v6, 5, v1
  v_lshl_add_u32 v6, v6, 4, v2
  v_lshlrev_b32 v53, 2, v6
  s_lshl_b32 s8, s3, 7
  v_add_u32 v53, s8, v53
  v_and_b32 v54, 31, v0
  v_lshlrev_b32 v54, 2, v54
  v_mov_b32 v61, s13
  v_mov_b32 v63, s13
  s_branch L_r_poll
L_r_retry:
  s_sleep 1
L_r_poll:
  buffer_load_dwordx4 v[116:119], v125, s[76:79], 0 offen sc1
  buffer_load_dwordx4 v[120:123], v125, s[76:79], s62 offen sc1
  buffer_load_dwordx4 v[112:115], v124, s[76:79], 0 offen sc1
  s_waitcnt vmcnt(0)
  v_xor_b32 v6, s13, v117
  v_xor_b32 v7, s13, v119
  v_or_b32 v6, v6, v7
  v_xor_b32 v7, s13, v121
  v_or_b32 v6, v6, v7
  v_xor_b32 v7, s13, v123
  v_or_b32 v6, v6, v7
  v_xor_b32 v7, s13, v113
  v_or_b32 v6, v6, v7
  v_xor_b32 v7, s13, v115
  v_or_b32 v6, v6, v7
  v_cmp_ne_u32 vcc, 0, v6
  s_sub_u32 s15, s15, 1
  s_cbranch_scc1 L_fin
  s_cbranch_vccnz L_r_retry
  v_max_f32 v128, v116, v120
  v_sub_f32 v126, v116, v128
  v_sub_f32 v127, v120, v128
  v_mul_f32 v126, 0x3fb8aa3b, v126
  v_mul_f32 v127, 0x3fb8aa3b, v127
  v_exp_f32 v126, v126
  v_exp_f32 v127, v127
  v_lshlrev_b32 v136, 16, v112
  v_and_b32 v137, 0xffff0000, v112
  v_lshlrev_b32 v138, 16, v114
  v_and_b32 v139, 0xffff0000, v114
  v_mul_f32 v129, v126, v118
  v_fmac_f32 v129, v127, v122
  v_rcp_f32 v129, v129
  v_cndmask_b32 v130, v126, v127, s[60:61]
  v_mul_f32 v130, v130, v129
  v_mul_f32 v136, v136, v130
  v_mul_f32 v137, v137, v130
  v_mul_f32 v138, v138, v130
  v_mul_f32 v139, v139, v130
  v_permlane32_swap_b32 v136, v137
  s_nop 0
  v_permlane32_swap_b32 v138, v139
  v_add_f32 v136, v136, v137
  v_add_f32 v138, v138, v139
  s_nop 1
  v_permlane16_swap_b32 v136, v138
  v_add_f32 v136, v136, v138
  s_nop 1
  v_add_f32_dpp v136, v136, v136 row_ror:8 row_mask:0xf bank_mask:0xf
  s_nop 1
  v_add_f32_dpp v136, v136, v136 row_ror:4 row_mask:0xf bank_mask:0xf
  ds_write_b32 v131, v136 offset:30720
  s_waitcnt lgkmcnt(0)
  s_barrier
  s_cmp_lg_u32 s3, 0
  s_cbranch_scc1 L_rdone
  ds_read_b32 v64, v132 offset:30720
  ds_read_b32 v65, v132 offset:30784
  ds_read_b32 v66, v132 offset:30848
  ds_read_b32 v67, v132 offset:30912
  v_lshlrev_b32 v48, 16, v48
  s_waitcnt lgkmcnt(0)
  v_add_f32 v64, v64, v65
  v_add_f32 v66, v66, v67
  v_add_f32 v64, v64, v66
  v_cvt_pk_bf16_f32 v64, v64, v64
  v_and_b32 v64, 0xffff0000, v64
  v_add_f32 v56, v64, v48
  s_nop 1
  v_mov_b32_dpp v57, v56 quad_perm:[1,0,3,2] row_mask:0xf bank_mask:0xf
  v_cvt_pk_bf16_f32 v60, v56, v57
  s_nop 1
  v_mov_b32_dpp v62, v60 quad_perm:[2,3,0,1] row_mask:0xf bank_mask:0xf
  buffer_store_dwordx4 v[60:63], v51, s[76:79], 0 offen sc1
  v_lshlrev_b32 v49, 16, v60
  s_nop 4
L_rdone:
  s_mov_b32 s60, 0x250000
  v_add_u32 v55, 0x50000, v50
  v_lshrrev_b32 v6, 4, v0
  v_cmp_gt_u32 s[62:63], 22, v6
  s_nop 1
  v_cndmask_b32 v55, v50, v55, s[62:63]
  s_branch L_o_poll
L_o_retry:
  s_sleep 1
L_o_poll:
  buffer_load_dwordx4 v[64:67], v50, s[76:79], s60 offen sc1
  buffer_load_dwordx4 v[68:71], v55, s[76:79], s60 offen sc1
  s_waitcnt vmcnt(0)
  v_xor_b32 v6, s13, v65
  v_xor_b32 v7, s13, v67
  v_or_b32 v6, v6, v7
  v_xor_b32 v7, s13, v69
  v_or_b32 v6, v6, v7
  v_xor_b32 v7, s13, v71
  v_or_b32 v6, v6, v7
  v_cmp_ne_u32 vcc, 0, v6
  s_sub_u32 s15, s15, 1
  s_cbranch_scc1 L_fin
  s_cbranch_vccnz L_o_retry
  s_cmp_eq_u32 s70, 0
  s_cbranch_scc1 L_bp0
  v_mov_b32 v64, v66
  v_mov_b32 v68, v70
L_bp0:
  v_cndmask_b32 v68, 0, v68, s[62:63]
  v_and_b32 v66, 0xffff0000, v64
  v_lshlrev_b32 v64, 16, v64
  v_and_b32 v70, 0xffff0000, v68
  v_lshlrev_b32 v68, 16, v68
  v_add_f32 v64, v64, v68
  v_add_f32 v66, v66, v70
  s_nop 1
  v_permlane32_swap_b32 v64, v66
  v_add_f32 v64, v64, v66
  v_mov_b32 v6, v64
  s_nop 1
  v_permlane16_swap_b32 v6, v64
  v_add_f32 v64, v64, v6
  ds_write_b32 v53, v64 offset:40960
  s_waitcnt lgkmcnt(0)
  s_barrier
  s_cmp_lg_u32 s3, 0
  s_cbranch_scc1 L_fin
  ds_read_b32 v64, v54 offset:40960
  ds_read_b32 v65, v54 offset:41088
  ds_read_b32 v66, v54 offset:41216
  ds_read_b32 v67, v54 offset:41344
  ds_read_b32 v68, v54 offset:41472
  ds_read_b32 v69, v54 offset:41600
  ds_read_b32 v70, v54 offset:41728
  ds_read_b32 v71, v54 offset:41856
  s_waitcnt lgkmcnt(0)
  v_add_f32 v64, v64, v65
  v_add_f32 v66, v66, v67
  v_add_f32 v68, v68, v69
  v_add_f32 v70, v70, v71
  v_add_f32 v64, v64, v66
  v_add_f32 v68, v68, v70
  v_add_f32 v64, v64, v68
  v_cvt_pk_bf16_f32 v64, v64, v64
  v_and_b32 v64, 0xffff0000, v64
  v_add_f32 v64, v64, v49
  v_cvt_pk_bf16_f32 v64, v64, v64
  buffer_store_short v64, v52, s[80:83], 0 offen
  s_cmp_lg_u32 s68, 0
  s_cbranch_scc1 L_fin
  v_mov_b32 v6, 0x45000
  v_mov_b32 v7, 0x7ffffff0
  v_cmp_eq_u32 vcc, 0, v0
  s_nop 1
  v_cndmask_b32 v6, v7, v6, vcc
  v_mov_b32 v8, s13
  buffer_store_dword v8, v6, s[76:79], 0 offen sc1
  s_branch L_fin
  s_nop 4
L_ffn:
  v_and_b32 v7, 3, v1
  s_mul_i32 s67, s66, 40960
  s_lshl_b32 s8, s3, 8
  s_add_u32 s67, s67, s8
  s_cmp_lt_u32 s3, 5
  s_cselect_b32 s67, s67, 0x40000000
  s_barrier
  buffer_load_dwordx4 v[228:231], v38, s[72:75], s64 offen
  s_add_u32 s64, s64, 55296
  buffer_load_dwordx4 v[232:235], v38, s[72:75], s64 offen
  s_add_u32 s64, s64, 55296
  buffer_load_dwordx4 v[236:239], v38, s[72:75], s64 offen
  s_add_u32 s64, s64, 55296
  buffer_load_dwordx4 v[240:243], v38, s[72:75], s64 offen
  s_add_u32 s64, s64, 55296
  buffer_load_dwordx4 v[244:247], v38, s[72:75], s64 offen
  s_add_u32 s64, s64, 55296
  buffer_load_dwordx4 v[152:155], v39, s[96:99], s67 offen
  s_add_u32 s67, s67, 5120
  buffer_load_dwordx4 v[156:159], v39, s[96:99], s67 offen
  s_add_u32 s67, s67, 5120
  buffer_load_dwordx4 v[160:163], v39, s[96:99], s67 offen
  s_add_u32 s67, s67, 5120
  buffer_load_dwordx4 v[164:167], v39, s[96:99], s67 offen
  s_add_u32 s67, s67, 5120
  buffer_load_dwordx4 v[168:171], v39, s[96:99], s67 offen
  s_add_u32 s67, s67, 5120
  buffer_load_dwordx4 v[172:175], v39, s[96:99], s67 offen
  s_add_u32 s67, s67, 5120
  buffer_load_dwordx4 v[176:179], v39, s[96:99], s67 offen
  s_add_u32 s67, s67, 5120
  buffer_load_dwordx4 v[180:183], v39, s[96:99], s67 offen
  s_add_u32 s67, s67, 5120
  s_lshr_b32 s8, s69, 1
  s_mul_i32 s8, s8, 5120
  s_and_b32 s9, s69, 1
  s_lshl_b32 s9, s9, 6
  s_add_u32 s8, s8, s9
  s_add_u32 s8, s8, 0x42000
  v_lshrrev_b32 v6, 2, v1
  v_lshlrev_b32 v142, 7, v6
  v_lshl_add_u32 v142, v7, 4, v142
  v_add_u32 v142, s8, v142
  v_add_u32 v143, 0x1000, v142
  v_cmp_gt_u32 s[60:61], 32, v1
  s_nop 1
  v_cndmask_b32 v143, v142, v143, s[60:61]
  s_mul_i32 s8, s69, 1280
  s_add_u32 s8, s8, 31744
  v_lshlrev_b32 v105, 3, v1
  v_add_u32 v105, s8, v105
  v_add_u32 v106, 1024, v105
  v_cndmask_b32 v106, v105, v106, s[60:61]
  v_mul_u32_u24 v104, 1280, v7
  v_lshl_add_u32 v104, v3, 4, v104
  s_mul_i32 s8, s69, 320
  v_add_u32 v104, s8, v104
  s_lshl_b32 s8, s3, 9
  v_lshlrev_b32 v109, 4, v2
  v_add_u32 v109, s8, v109
  v_lshlrev_b32 v110, 2, v1
  v_lshlrev_b32 v111, 3, v7
  v_lshlrev_b32 v108, 6, v7
  v_lshl_add_u32 v108, v6, 1, v108
  v_add_u32 v108, s8, v108
  v_lshlrev_b32 v8, 6, v7
  v_lshl_add_u32 v8, v3, 4, v8
  v_add_u32 v8, s8, v8
  s_add_u32 s9, s8, 256
  v_mov_b32 v7, s9
  v_lshrrev_b32 v6, 2, v2
  v_cmp_eq_u32 vcc, 0, v6
  s_nop 1
  v_cndmask_b32 v184, v7, v8, vcc
  v_cmp_eq_u32 vcc, 1, v6
  s_nop 1
  v_cndmask_b32 v185, v7, v8, vcc
  v_cmp_eq_u32 vcc, 2, v6
  s_nop 1
  v_cndmask_b32 v186, v7, v8, vcc
  v_cmp_eq_u32 vcc, 3, v6
  s_nop 1
  v_cndmask_b32 v187, v7, v8, vcc
  v_mov_b32 v64, 0
  v_mov_b32 v65, 0
  v_mov_b32 v66, 0
  v_mov_b32 v67, 0
  v_mov_b32 v68, 0
  v_mov_b32 v69, 0
  v_mov_b32 v70, 0
  v_mov_b32 v71, 0
  v_mov_b32 v72, 0
  v_mov_b32 v73, 0
  v_mov_b32 v74, 0
  v_mov_b32 v75, 0
  v_mov_b32 v76, 0
  v_mov_b32 v77, 0
  v_mov_b32 v78, 0
  v_mov_b32 v79, 0
  ds_write_b128 v7, v[64:67] offset:5120
  v_mov_b32 v81, s13
  v_mov_b32 v83, s13
  v_mov_b32 v85, s13
  v_mov_b32 v87, s13
  s_mul_i32 s8, s66, 10240
  s_lshl_b32 s9, s3, 11
  s_add_u32 s8, s8, s9
  s_add_u32 s8, s8, 0x250000
  v_add_u32 v107, s8, v4
  s_mul_i32 s8, s3, 10240
  v_add_u32 v48, s8, v4
  v_bfe_u32 v6, v1, 2, 2
  v_lshl_add_u32 v6, v3, 3, v6
  v_and_b32 v8, 3, v1
  v_lshlrev_b32 v8, 3, v8
  v_add_u32 v8, s8, v8
  v_lshl_add_u32 v49, v6, 6, v8
  v_lshl_add_u32 v51, v6, 8, v8
  v_lshlrev_b32 v50, 8, v3
  v_lshl_add_u32 v50, v2, 4, v50
  v_add_u32 v50, s8, v50
  v_mov_b32 v192, 0x3f803f80
  v_mov_b32 v193, 0x3f803f80
  v_mov_b32 v194, 0x3f803f80
  v_mov_b32 v195, 0x3f803f80
  v_mov_b32 v196, 0
  v_mov_b32 v197, 0
  v_mov_b32 v198, 0
  v_mov_b32 v199, 0
  v_mov_b32 v200, 0
  v_mov_b32 v201, 0
  v_mov_b32 v202, 0
  v_mov_b32 v203, 0
  s_waitcnt vmcnt(8)
  ds_write_b128 v48, v[208:211] offset:43008
  ds_write_b128 v48, v[212:215] offset:44032
  ds_write_b128 v48, v[216:219] offset:45056
  ds_write_b128 v48, v[220:223] offset:46080
  ds_write_b128 v48, v[224:227] offset:47104
  ds_write_b128 v48, v[228:231] offset:48128
  ds_write_b128 v48, v[232:235] offset:49152
  ds_write_b128 v48, v[236:239] offset:50176
  ds_write_b128 v48, v[240:243] offset:51200
  ds_write_b128 v48, v[244:247] offset:52224
  s_waitcnt lgkmcnt(0)
  ds_read_b64_tr_b16 v[208:209], v49 offset:43008
  ds_read_b64_tr_b16 v[210:211], v49 offset:43264
  ds_read_b64_tr_b16 v[212:213], v49 offset:43040
  ds_read_b64_tr_b16 v[214:215], v49 offset:43296
  ds_read_b64_tr_b16 v[216:217], v49 offset:45056
  ds_read_b64_tr_b16 v[218:219], v49 offset:45312
  ds_read_b64_tr_b16 v[220:221], v49 offset:45088
  ds_read_b64_tr_b16 v[222:223], v49 offset:45344
  ds_read_b64_tr_b16 v[224:225], v49 offset:47104
  ds_read_b64_tr_b16 v[226:227], v49 offset:47360
  ds_read_b64_tr_b16 v[228:229], v49 offset:47136
  ds_read_b64_tr_b16 v[230:231], v49 offset:47392
  s_waitcnt lgkmcnt(0)
  ds_read_b64_tr_b16 v[232:233], v49 offset:49152
  ds_read_b64_tr_b16 v[234:235], v49 offset:49408
  ds_read_b64_tr_b16 v[236:237], v49 offset:49184
  ds_read_b64_tr_b16 v[238:239], v49 offset:49440
  ds_read_b64_tr_b16 v[240:241], v49 offset:51200
  ds_read_b64_tr_b16 v[242:243], v49 offset:51456
  ds_read_b64_tr_b16 v[244:245], v49 offset:51232
  ds_read_b64_tr_b16 v[246:247], v49 offset:51488
  s_waitcnt lgkmcnt(0)
  v_mfma_f32_16x16x32_bf16 v[196:199], v[192:195], v[208:211], v[196:199]
  v_mfma_f32_16x16x32_bf16 v[200:203], v[192:195], v[212:215], v[200:203]
  v_mfma_f32_16x16x32_bf16 v[196:199], v[192:195], v[216:219], v[196:199]
  v_mfma_f32_16x16x32_bf16 v[200:203], v[192:195], v[220:223], v[200:203]
  v_mfma_f32_16x16x32_bf16 v[196:199], v[192:195], v[224:227], v[196:199]
  v_mfma_f32_16x16x32_bf16 v[200:203], v[192:195], v[228:231], v[200:203]
  v_mfma_f32_16x16x32_bf16 v[196:199], v[192:195], v[232:235], v[196:199]
  v_mfma_f32_16x16x32_bf16 v[200:203], v[192:195], v[236:239], v[200:203]
  v_mfma_f32_16x16x32_bf16 v[196:199], v[192:195], v[240:243], v[196:199]
  v_mfma_f32_16x16x32_bf16 v[200:203], v[192:195], v[244:247], v[200:203]
  s_waitcnt vmcnt(0)
  ds_write_b128 v50, v[152:155] offset:43008
  ds_write_b128 v50, v[156:159] offset:44032
  ds_write_b128 v50, v[160:163] offset:45056
  ds_write_b128 v50, v[164:167] offset:46080
  ds_write_b128 v50, v[168:171] offset:47104
  ds_write_b128 v50, v[172:175] offset:48128
  ds_write_b128 v50, v[176:179] offset:49152
  ds_write_b128 v50, v[180:183] offset:50176
  s_lshl_b32 s8, s3, 7
  v_lshlrev_b32 v6, 2, v2
  v_add_u32 v6, s8, v6
  ds_write_b32 v6, v196 offset:4096
  ds_write_b32 v6, v200 offset:4160
  s_waitcnt lgkmcnt(0)
  ds_read_b64_tr_b16 v[152:153], v51 offset:43008
  ds_read_b64_tr_b16 v[154:155], v51 offset:44032
  ds_read_b64_tr_b16 v[156:157], v51 offset:43040
  ds_read_b64_tr_b16 v[158:159], v51 offset:44064
  ds_read_b64_tr_b16 v[160:161], v51 offset:43072
  ds_read_b64_tr_b16 v[162:163], v51 offset:44096
  ds_read_b64_tr_b16 v[164:165], v51 offset:43104
  ds_read_b64_tr_b16 v[166:167], v51 offset:44128
  s_waitcnt lgkmcnt(0)
  ds_read_b64_tr_b16 v[168:169], v51 offset:43136
  ds_read_b64_tr_b16 v[170:171], v51 offset:44160
  ds_read_b64_tr_b16 v[172:173], v51 offset:43168
  ds_read_b64_tr_b16 v[174:175], v51 offset:44192
  ds_read_b64_tr_b16 v[176:177], v51 offset:43200
  ds_read_b64_tr_b16 v[178:179], v51 offset:44224
  ds_read_b64_tr_b16 v[180:181], v51 offset:43232
  ds_read_b64_tr_b16 v[182:183], v51 offset:44256
  v_lshrrev_b32 v6, 2, v1
  v_lshlrev_b32 v6, 2, v6
  v_add_u32 v6, 4096, v6
  s_waitcnt lgkmcnt(0)
  s_barrier
  ds_read2_b32 v[48:49], v6 offset0:0 offset1:16
  ds_read2_b32 v[50:51], v6 offset0:32 offset1:48
  ds_read2_b32 v[52:53], v6 offset0:64 offset1:80
  ds_read2_b32 v[54:55], v6 offset0:96 offset1:112
  ds_read2_b32 v[56:57], v6 offset0:128 offset1:144
  ds_read2_b32 v[58:59], v6 offset0:160 offset1:176
  ds_read2_b32 v[60:61], v6 offset0:192 offset1:208
  ds_read2_b32 v[62:63], v6 offset0:224 offset1:240
  s_waitcnt lgkmcnt(0)
  v_pk_add_f32 v[48:49], v[48:49], v[50:51]
  v_pk_add_f32 v[52:53], v[52:53], v[54:55]
  v_pk_add_f32 v[56:57], v[56:57], v[58:59]
  v_pk_add_f32 v[60:61], v[60:61], v[62:63]
  v_pk_add_f32 v[188:189], v[48:49], v[52:53]
  v_pk_add_f32 v[190:191], v[56:57], v[60:61]
  s_branch L_g_poll
L_g_retry:
  s_sleep 1
L_g_poll:
  buffer_load_dwordx4 v[112:115], v142, s[76:79], 0 offen sc1
  buffer_load_dwordx4 v[116:119], v142, s[76:79], 0 offen offset:2048 sc1
  buffer_load_dwordx4 v[120:123], v143, s[76:79], 0 offen sc1
  s_waitcnt vmcnt(0)
  v_xor_b32 v6, s13, v113
  v_xor_b32 v7, s13, v115
  v_or_b32 v6, v6, v7
  v_xor_b32 v7, s13, v117
  v_or_b32 v6, v6, v7
  v_xor_b32 v7, s13, v119
  v_or_b32 v6, v6, v7
  v_xor_b32 v7, s13, v121
  v_or_b32 v6, v6, v7
  v_xor_b32 v7, s13, v123
  v_or_b32 v6, v6, v7
  v_cmp_ne_u32 vcc, 0, v6
  s_sub_u32 s15, s15, 1
  s_cbranch_scc1 L_fin
  s_cbranch_vccnz L_g_retry
  s_cmp_ge_u32 s3, 4
  s_cbranch_scc1 L_lnskip
  ds_write2_b32 v105, v112, v114 offset0:0 offset1:1
  ds_write2_b32 v105, v116, v118 offset0:128 offset1:129
  ds_write2_b32 v106, v120, v122 offset0:0 offset1:1
  s_waitcnt lgkmcnt(0)
L_lnskip:
  s_barrier
  ds_read_b128 v[192:195], v104 offset:31744
  ds_read_b128 v[196:199], v104 offset:31808
  ds_read_b128 v[200:203], v104 offset:31872
  ds_read_b128 v[204:207], v104 offset:31936
  ds_read_b128 v[144:147], v104 offset:32000
  s_waitcnt lgkmcnt(4)
  v_mfma_f32_16x16x32_bf16 v[64:67], v[192:195], v[208:211], v[64:67]
  v_mfma_f32_16x16x32_bf16 v[68:71], v[192:195], v[212:215], v[68:71]
  s_waitcnt lgkmcnt(3)
  v_mfma_f32_16x16x32_bf16 v[64:67], v[196:199], v[216:219], v[64:67]
  v_mfma_f32_16x16x32_bf16 v[68:71], v[196:199], v[220:223], v[68:71]
  s_waitcnt lgkmcnt(2)
  v_mfma_f32_16x16x32_bf16 v[64:67], v[200:203], v[224:227], v[64:67]
  v_mfma_f32_16x16x32_bf16 v[68:71], v[200:203], v[228:231], v[68:71]
  s_waitcnt lgkmcnt(1)
  v_mfma_f32_16x16x32_bf16 v[64:67], v[204:207], v[232:235], v[64:67]
  v_mfma_f32_16x16x32_bf16 v[68:71], v[204:207], v[236:239], v[68:71]
  s_waitcnt lgkmcnt(0)
  v_mfma_f32_16x16x32_bf16 v[64:67], v[144:147], v[240:243], v[64:67]
  v_mfma_f32_16x16x32_bf16 v[68:71], v[144:147], v[244:247], v[68:71]
  s_cmp_lt_u32 s3, 4
  s_cbranch_scc1 L_stskip
  v_permlane32_swap_b32 v120, v122
  v_lshlrev_b32 v124, 16, v112
  v_and_b32 v125, 0xffff0000, v112
  v_lshlrev_b32 v126, 16, v114
  v_and_b32 v127, 0xffff0000, v114
  v_lshlrev_b32 v128, 16, v116
  v_and_b32 v129, 0xffff0000, v116
  v_lshlrev_b32 v130, 16, v118
  v_and_b32 v131, 0xffff0000, v118
  v_lshlrev_b32 v132, 16, v120
  v_and_b32 v133, 0xffff0000, v120
  v_add_f32 v134, v124, v125
  v_mul_f32 v135, v124, v124
  v_fmac_f32 v135, v125, v125
  v_add_f32 v134, v134, v126
  v_fmac_f32 v135, v126, v126
  v_add_f32 v134, v134, v127
  v_fmac_f32 v135, v127, v127
  v_add_f32 v134, v134, v128
  v_fmac_f32 v135, v128, v128
  v_add_f32 v134, v134, v129
  v_fmac_f32 v135, v129, v129
  v_add_f32 v134, v134, v130
  v_fmac_f32 v135, v130, v130
  v_add_f32 v134, v134, v131
  v_fmac_f32 v135, v131, v131
  v_add_f32 v134, v134, v132
  v_fmac_f32 v135, v132, v132
  v_add_f32 v134, v134, v133
  v_fmac_f32 v135, v133, v133
  s_nop 0
  v_add_f32_dpp v134, v134, v134 row_ror:8 row_mask:0xf bank_mask:0xf
  v_add_f32_dpp v135, v135, v135 row_ror:8 row_mask:0xf bank_mask:0xf
  s_nop 0
  v_add_f32_dpp v134, v134, v134 row_ror:4 row_mask:0xf bank_mask:0xf
  v_add_f32_dpp v135, v135, v135 row_ror:4 row_mask:0xf bank_mask:0xf
  s_nop 0
  v_add_f32_dpp v134, v134, v134 row_ror:2 row_mask:0xf bank_mask:0xf
  v_add_f32_dpp v135, v135, v135 row_ror:2 row_mask:0xf bank_mask:0xf
  s_nop 0
  v_add_f32_dpp v134, v134, v134 row_ror:1 row_mask:0xf bank_mask:0xf
  v_add_f32_dpp v135, v135, v135 row_ror:1 row_mask:0xf bank_mask:0xf
  s_nop 1
  v_permlane32_swap_b32 v134, v135
  v_add_f32 v134, v134, v135
  v_mov_b32 v136, v134
  s_nop 1
  v_permlane16_swap_b32 v136, v134
  v_add_f32 v134, v134, v136
  v_mov_b32 v135, v134
  s_nop 1
  v_permlane32_swap_b32 v134, v135
  v_mul_f32 v137, 0x3acccccd, v134
  v_mul_f32 v135, 0x3acccccd, v135
  v_fma_f32 v135, -v137, v137, v135
  v_max_f32 v135, 0, v135
  v_cvt_pk_bf16_f32 v136, v137, v135
  v_lshlrev_b32 v138, 16, v136
  v_and_b32 v135, 0xffff0000, v136
  v_add_f32 v135, 0x3727c5ac, v135
  v_cvt_pk_bf16_f32 v135, v135, v135
  v_and_b32 v135, 0xffff0000, v135
  v_sqrt_f32 v139, v135
  s_nop 0
  v_cvt_pk_bf16_f32 v139, v139, v139
  v_and_b32 v139, 0xffff0000, v139
  v_rcp_f32 v139, v139
  s_lshl_b32 s8, s69, 3
  v_mov_b32 v6, s8
  ds_write_b64 v6, v[138:139] offset:42000
L_stskip:
  s_nop 7
  ds_write_b128 v109, v[64:67] offset:0
  ds_write_b128 v109, v[68:71] offset:256
  s_waitcnt lgkmcnt(0)
  s_barrier
  s_cmp_ge_u32 s3, 5
  s_cbranch_scc1 L_fin
  ds_read_b64 v[192:193], v111 offset:42000
  ds_read2_b32 v[48:49], v110 offset0:0 offset1:64
  ds_read2_b32 v[50:51], v110 offset0:128 offset1:192
  ds_read2st64_b32 v[52:53], v110 offset0:4 offset1:5
  ds_read2st64_b32 v[54:55], v110 offset0:6 offset1:7
  ds_read2st64_b32 v[56:57], v110 offset0:8 offset1:9
  ds_read2st64_b32 v[58:59], v110 offset0:10 offset1:11
  ds_read2st64_b32 v[60:61], v110 offset0:12 offset1:13
  ds_read2st64_b32 v[62:63], v110 offset0:14 offset1:15
  s_waitcnt lgkmcnt(0)
  v_pk_add_f32 v[48:49], v[48:49], v[50:51]
  v_pk_add_f32 v[52:53], v[52:53], v[54:55]
  v_pk_add_f32 v[56:57], v[56:57], v[58:59]
  v_pk_add_f32 v[60:61], v[60:61], v[62:63]
  v_pk_add_f32 v[48:49], v[48:49], v[52:53]
  v_pk_add_f32 v[56:57], v[56:57], v[60:61]
  v_fma_f32 v48, -v192, v188, v48
  v_fma_f32 v56, -v192, v190, v56
  v_fma_f32 v49, -v192, v189, v49
  v_fma_f32 v57, -v192, v191, v57
  v_mul_f32 v48, v48, v193
  v_mul_f32 v56, v56, v193
  v_mul_f32 v49, v49, v193
  v_mul_f32 v57, v57, v193
  v_cvt_pk_bf16_f32 v50, v48, v56
  v_cvt_pk_bf16_f32 v51, v49, v57
  v_lshlrev_b32 v48, 16, v50
  v_and_b32 v56, 0xffff0000, v50
  v_lshlrev_b32 v49, 16, v51
  v_and_b32 v57, 0xffff0000, v51
  v_mul_f32 v52, v48, v48
  v_mul_f32 v53, v49, v49
  v_mul_f32 v52, 0x3d372713, v52
  v_mul_f32 v53, 0x3d372713, v53
  v_fma_f32 v54, v52, v48, v48
  v_fma_f32 v55, v53, v49, v49
  v_mul_f32 v54, 0xc0135761, v54
  v_mul_f32 v55, 0xc0135761, v55
  v_exp_f32 v54, v54
  v_exp_f32 v55, v55
  v_add_f32 v54, 1.0, v54
  v_add_f32 v55, 1.0, v55
  v_rcp_f32 v54, v54
  v_rcp_f32 v55, v55
  v_mul_f32 v48, v48, v54
  v_mul_f32 v49, v49, v55
  v_cvt_pk_bf16_f32 v50, v48, v49
  v_lshlrev_b32 v48, 16, v50
  v_and_b32 v49, 0xffff0000, v50
  v_mul_f32 v48, v48, v56
  v_mul_f32 v49, v49, v57
  v_cvt_pk_bf16_f32 v50, v48, v49
  ds_write_b16 v108, v50 offset:5120
  ds_write_b16_d16_hi v108, v50 offset:5152
  s_waitcnt lgkmcnt(0)
  ds_read_b128 v[88:91], v184 offset:5120
  ds_read_b128 v[92:95], v185 offset:5120
  ds_read_b128 v[96:99], v186 offset:5120
  ds_read_b128 v[100:103], v187 offset:5120
  s_waitcnt lgkmcnt(3)
  v_mfma_f32_16x16x32_bf16 v[72:75], v[88:91], v[152:155], v[72:75]
  v_mfma_f32_16x16x32_bf16 v[76:79], v[88:91], v[168:171], v[76:79]
  s_waitcnt lgkmcnt(2)
  v_mfma_f32_16x16x32_bf16 v[72:75], v[92:95], v[156:159], v[72:75]
  v_mfma_f32_16x16x32_bf16 v[76:79], v[92:95], v[172:175], v[76:79]
  s_waitcnt lgkmcnt(1)
  v_mfma_f32_16x16x32_bf16 v[72:75], v[96:99], v[160:163], v[72:75]
  v_mfma_f32_16x16x32_bf16 v[76:79], v[96:99], v[176:179], v[76:79]
  s_waitcnt lgkmcnt(0)
  v_mfma_f32_16x16x32_bf16 v[72:75], v[100:103], v[164:167], v[72:75]
  v_mfma_f32_16x16x32_bf16 v[76:79], v[100:103], v[180:183], v[76:79]
  s_nop 6
  v_cvt_pk_bf16_f32 v80, v72, v73
  v_cvt_pk_bf16_f32 v82, v74, v75
  buffer_store_dwordx4 v[80:83], v107, s[76:79], 0 offen offset:0 sc1
  v_cvt_pk_bf16_f32 v84, v76, v77
  v_cvt_pk_bf16_f32 v86, v78, v79
  buffer_store_dwordx4 v[84:87], v107, s[76:79], 0 offen offset:1024 sc1
  s_nop 4
L_fin:
L_end:
  s_endpgm
.section .rodata,"a"
.p2align 6
.amdhsa_kernel sequential_preLN__gqa_block_cached__geglu_ffn__decode_kernel
  .amdhsa_next_free_vgpr 248
  .amdhsa_next_free_sgpr 102
  .amdhsa_accum_offset 248
  .amdhsa_group_segment_fixed_size 0
  .amdhsa_kernarg_size 96
  .amdhsa_user_sgpr_count 2
  .amdhsa_user_sgpr_kernarg_segment_ptr 1
  .amdhsa_system_sgpr_workgroup_id_x 1
.end_amdhsa_kernel
```
